```python
import torch

def _softmax(x, axis=-1):
    return torch.softmax(x, dim=axis)
def _gelu(x):
    return torch.nn.functional.gelu(x, approximate="tanh")
def _silu(x):
    return torch.nn.functional.silu(x)
def _sigmoid(x):
    return torch.sigmoid(x)
def _layernorm(x, axis=-1, eps=1e-5):
    m = x.mean(dim=axis, keepdim=True)
    v = x.var(dim=axis, keepdim=True, unbiased=False)
    return (x - m) / torch.sqrt(v + eps)
def _scatter_add(tgt, idx, src, axis=0):
    return tgt.clone().index_add_(axis, idx, src)
def _segment_sum(src, seg, n):
    out = torch.zeros((n,) + src.shape[1:], dtype=src.dtype)
    return out.index_add_(0, seg, src)
def _pad(x, pw):
    flat = tuple(v for pair in reversed(pw) for v in pair)
    return torch.nn.functional.pad(x, flat)

kernel_name = 'concat_heads__grouped_kv_mqa__ssm_conv_s5__prompt'

def setup_inputs():

    _w = (lambda a: (lambda t: t.to(torch.bfloat16) if t.is_floating_point() else t)(torch.as_tensor(a)))
    def _A_setup():
        B, S, D, H = 1, 2048, 512, 32
        Dh = D // H
        return {
            "x": _w((lambda *s: torch.randn(*s, dtype=torch.bfloat16) * 0.05)(B, S, D)),
            "wq": _w((lambda *s: torch.randn(*s, dtype=torch.bfloat16) * 0.8)(D, H * Dh)),
            "wk": _w((lambda *s: torch.randn(*s, dtype=torch.bfloat16) * 0.8)(D, Dh)),
            "wv": _w((lambda *s: torch.randn(*s, dtype=torch.bfloat16) * 0.05)(D, Dh)),
            "wo": _w((lambda *s: torch.randn(*s, dtype=torch.bfloat16) * 0.05)(H * Dh, D)),
        }
    _A_in = _A_setup()

    def _B_setup():
        B, S, D = 1, 2048, 512
        P = D
        Lambda_re = -0.5 * (lambda _x: torch.exp(torch.as_tensor(_x)))((lambda *s: torch.randn(*s, dtype=torch.bfloat16) * 0.2)(P))
        Lambda_im = (lambda *s: torch.randn(*s, dtype=torch.bfloat16) * 0.4)(P) * 1.0
        B_re = (lambda *s: torch.randn(*s, dtype=torch.bfloat16) * 0.2)(P, D) * (D ** -0.5)
        B_im = (lambda *s: torch.randn(*s, dtype=torch.bfloat16) * 0.2)(P, D) * (D ** -0.5)
        C_re = (lambda *s: torch.randn(*s, dtype=torch.bfloat16) * 0.2)(D, P) * (P ** -0.5)
        C_im = (lambda *s: torch.randn(*s, dtype=torch.bfloat16) * 0.2)(D, P) * (P ** -0.5)
        log_dt = (lambda *s: torch.randn(*s, dtype=torch.bfloat16) * 0.2)(P) * 0.3 - 2.0
        Dskip = (lambda *s: torch.randn(*s, dtype=torch.bfloat16) * 0.05)(D)
        return {
            "x": _w((lambda *s: torch.randn(*s, dtype=torch.bfloat16) * 0.05)(B, S, D)),
            "Lambda_re": _w(Lambda_re),
            "Lambda_im": _w(Lambda_im),
            "B_re": _w(B_re),
            "B_im": _w(B_im),
            "C_re": _w(C_re),
            "C_im": _w(C_im),
            "log_dt": _w(log_dt),
            "Dskip": _w(Dskip),
        }
    _B_in = _B_setup()

    return {
        "A_x": _A_in["x"],
        "A_wq": _A_in["wq"],
        "A_wk": _A_in["wk"],
        "A_wv": _A_in["wv"],
        "A_wo": _A_in["wo"],
        "B_x": _B_in["x"],
        "B_Lambda_re": _B_in["Lambda_re"],
        "B_Lambda_im": _B_in["Lambda_im"],
        "B_B_re": _B_in["B_re"],
        "B_B_im": _B_in["B_im"],
        "B_C_re": _B_in["C_re"],
        "B_C_im": _B_in["C_im"],
        "B_log_dt": _B_in["log_dt"],
        "B_Dskip": _B_in["Dskip"],
    }

def reference(A_x, A_wq, A_wk, A_wv, A_wo, B_x, B_Lambda_re, B_Lambda_im, B_B_re, B_B_im, B_C_re, B_C_im, B_log_dt, B_Dskip):
    def _A_ref(x, wq, wk, wv, wo):
        B, S, D = x.shape
        H = 32
        Dh = D // H
        q = (lambda x, *d: x.permute(*d))((x @ wq).reshape(B, S, H, Dh), 0, 2, 1, 3)
        k = x @ wk
        v = x @ wv
        scores = torch.einsum("bhqd,bkd->bhqk", q, k) * (Dh ** -0.5)
        p = _softmax(scores, axis=-1)
        o = torch.einsum("bhqk,bkd->bhqd", p, v)
        return (lambda x, *d: x.permute(*d))(o, 0, 2, 1, 3).reshape(B, S, H * Dh) @ wo

    def _B_ref(x, Lambda_re, Lambda_im, B_re, B_im, C_re, C_im, log_dt, Dskip):
        Bsz, L, H = x.shape
        Lam = Lambda_re + 1j * Lambda_im
        Bmat = B_re + 1j * B_im
        Cmat = C_re + 1j * C_im
        dt = torch.exp(log_dt)
        Lam_bar = torch.exp(dt * Lam)
        B_bar = ((Lam_bar - 1.0) / Lam)[:, None] * Bmat
        Bu = torch.einsum("bld,pd->blp", x + 0j, B_bar)
        h = torch.zeros_like(Bu[:, 0, :])
        hs = []
        for t in range(L):
            h = Lam_bar[None, :] * h + Bu[:, t, :]
            hs.append(h)
        hseq = torch.stack(hs, 1)
        y = 2.0 * torch.einsum("blp,dp->bld", hseq, Cmat).real + x * Dskip[None, None, :]
        return y

    a = _A_ref(A_x, A_wq, A_wk, A_wv, A_wo)
    b = _B_ref(B_x, B_Lambda_re, B_Lambda_im, B_B_re, B_B_im, B_C_re, B_C_im, B_log_dt, B_Dskip)
    return torch.concatenate([a, b], axis=-1)
```

```asm
; @launch grid=(256,1,1) block=(512,1,1) lds=163840
.amdgcn_target "amdgcn-amd-amdhsa--gfx950"
.text
.globl concat_heads__grouped_kv_mqa__ssm_conv_s5__prompt_kernel
.p2align 8
.type concat_heads__grouped_kv_mqa__ssm_conv_s5__prompt_kernel,@function
concat_heads__grouped_kv_mqa__ssm_conv_s5__prompt_kernel:
.set NSYNC_B2, 28
    s_cmp_ge_u32 s2, 256
    s_cbranch_scc1 L_exit
    s_load_dwordx16 s[16:31], s[0:1], 0
    s_load_dwordx16 s[32:47], s[0:1], 64
    s_load_dwordx2 s[48:49], s[0:1], 128
    v_lshrrev_b32 v1, 6, v0
    v_and_b32 v0, 63, v0
    v_readfirstlane_b32 s3, v1
    v_lshlrev_b32 v6, 4, v0
    v_lshrrev_b32 v12, 4, v0
    v_and_b32 v13, 15, v0
    s_and_b32 s9, s2, 7
    s_lshr_b32 s10, s2, 3
    s_and_b32 s11, s10, 3
    s_lshl_b32 s5, s9, 2
    s_add_u32 s5, s5, s11
    s_lshr_b32 s6, s10, 2
    s_and_b32 s70, s6, 3
    s_and_b32 s15, s3, 3
    s_mov_b32 s72, 0
    s_mov_b32 s58, 2097152
    s_mov_b32 s59, 0x20000
    s_mov_b32 s63, 0x20000
    s_cmp_ge_u32 s3, 4
    s_cbranch_scc1 L_attn
    s_setprio 3
    v_add_u32 v14, 0, v12
    v_xor_b32 v15, v13, v14
    v_lshlrev_b32 v15, 4, v15
    v_lshl_add_u32 v16, v14, 10, v15
    v_add_u32 v14, 4, v12
    v_xor_b32 v15, v13, v14
    v_lshlrev_b32 v15, 4, v15
    v_lshl_add_u32 v17, v14, 10, v15
    v_add_u32 v14, 8, v12
    v_xor_b32 v15, v13, v14
    v_lshlrev_b32 v15, 4, v15
    v_lshl_add_u32 v18, v14, 10, v15
    v_add_u32 v14, 12, v12
    v_xor_b32 v15, v13, v14
    v_lshlrev_b32 v15, 4, v15
    v_lshl_add_u32 v19, v14, 10, v15
    s_and_b32 s7, s9, 6
    s_lshl_b32 s7, s7, 1
    s_add_u32 s7, s7, s11
    s_and_b32 s8, s9, 1
    s_lshl_b32 s8, s8, 3
    s_add_u32 s8, s8, s6
    s_lshr_b32 s71, s6, 2
    s_lshl_b32 s12, s8, 5
    v_and_b32 v38, 31, v0
    v_add_lshl_u32 v37, v38, s12, 1
    s_mov_b32 s100, s6
    s_and_b32 s12, s15, 1
    s_lshl1_add_u32 s12, s100, s12
    s_lshl_b32 s12, s12, 5
    v_add_lshl_u32 v38, v38, s12, 1
    s_add_u32 s12, s72, s15
    s_and_b32 s12, s12, 3
    s_lshl_b32 s9, s5, 16
    s_lshl_b32 s10, s70, 14
    s_add_u32 s9, s9, s10
    s_lshl_b32 s10, s12, 8
    s_add_u32 s9, s9, s10
    s_lshl_b32 s11, s70, 12
    s_lshl_b32 s10, s15, 14
    s_add_u32 s11, s11, s10
    s_lshl_b32 s12, s12, 12
    s_lshl_b32 s13, s15, 12
    s_add_u32 s13, s13, 140288
    s_mov_b32 s62, 16384
    s_mov_b32 m0, s11
    s_cmp_eq_u32 s71, 0
    s_waitcnt lgkmcnt(0)
    s_cselect_b32 s60, s20, s22
    s_cselect_b32 s61, s21, s23
    s_mov_b32 s56, s16
    s_and_b32 s57, s17, 0xffff
    s_and_b32 s61, s61, 0xffff
    buffer_load_dwordx4 v16, s[56:59], s9 offen lds
    s_add_u32 m0, s11, 1024
    s_nop 0
    buffer_load_dwordx4 v17, s[56:59], s9 offen lds
    s_add_u32 m0, s11, 2048
    s_nop 0
    buffer_load_dwordx4 v18, s[56:59], s9 offen lds
    s_add_u32 m0, s11, 3072
    s_nop 0
    buffer_load_dwordx4 v19, s[56:59], s9 offen lds
    s_mov_b32 m0, s13
    s_nop 0
    buffer_load_dwordx4 v6, s[60:63], s12 offen lds
    buffer_load_dwordx4 v6, s[60:63], s12 offen offset:1024 lds
    buffer_load_dwordx4 v6, s[60:63], s12 offen offset:2048 lds
    buffer_load_dwordx4 v6, s[60:63], s12 offen offset:3072 lds
    global_load_ushort v60, v37, s[28:29]
    global_load_ushort v61, v37, s[30:31]
    global_load_ushort v62, v37, s[40:41]
    global_load_ushort v63, v38, s[42:43]
    s_load_dword s4, s[48:49], 0
L_h_noep:
    s_barrier
    s_mov_b32 s52, s48
    s_and_b32 s53, s49, 0xffff
    s_mov_b32 s54, 16777216
    s_mov_b32 s55, 0x20000
    v_xor_b32 v14, v12, v13
    v_lshlrev_b32 v14, 4, v14
    v_lshl_add_u32 v14, v13, 8, v14
    v_add_u32 v8, s11, v14
    v_xor_b32 v9, 64, v8
    v_xor_b32 v10, 128, v8
    v_xor_b32 v11, 192, v8
    v_lshrrev_b32 v14, 2, v13
    v_lshl_add_u32 v14, v12, 3, v14
    v_lshlrev_b32 v14, 5, v14
    v_and_b32 v15, 3, v0
    v_lshl_add_u32 v14, v15, 3, v14
    v_add_u32 v14, s13, v14
    s_lshl_b32 s9, s15, 10
    s_add_u32 s9, s9, 131072
    v_add_u32 v15, s9, v6
    s_lshl_b32 s9, s5, 2
    s_add_u32 s9, s9, s70
    s_lshr_b32 s10, s9, 1
    s_lshl_b32 s10, s10, 1
    s_add_u32 s10, s10, s71
    s_lshl_b32 s10, s10, 10
    s_and_b32 s11, s9, 1
    s_add_u32 s12, s71, 8
    s_lshl_b32 s11, s11, s12
    s_add_u32 s10, s10, s11
    s_add_u32 s50, s10, 262144
    s_lshl_b32 s9, s9, 1
    s_add_u32 s9, s9, s71
    s_lshl_b32 s9, s9, 6
    s_add_u32 s51, s9, 4096
    s_cmp_eq_u32 s71, 0
    s_cselect_b32 s9, 9, 3
    s_cselect_b32 s10, 3, 8
    v_and_b32 v34, 1, v12
    v_lshrrev_b32 v35, 1, v12
    v_lshlrev_b32 v16, 4, v13
    v_lshl_add_u32 v16, v34, s9, v16
    v_lshl_add_u32 v16, v35, s10, v16
    v_mov_b32 v2, 159744
    v_mov_b32 v3, 1
    s_waitcnt lgkmcnt(0)
    s_mul_i32 s4, s4, 1664525
    s_add_u32 s4, s4, 1013904223
    v_mov_b32 v36, s4
    ds_write_b32 v2, v36 offset:28
L_h_notag:
    s_cmp_eq_u32 s71, 0
    s_waitcnt vmcnt(4)
    ds_read_b128 v[128:131], v8
    ds_read_b64_tr_b16 v[132:133], v14 offset:0
    ds_read_b64_tr_b16 v[134:135], v14 offset:128
    ds_read_b128 v[136:139], v9
    ds_read_b64_tr_b16 v[140:141], v14 offset:1024
    ds_read_b64_tr_b16 v[142:143], v14 offset:1152
    ds_read_b128 v[144:147], v10
    ds_read_b64_tr_b16 v[148:149], v14 offset:2048
    ds_read_b64_tr_b16 v[150:151], v14 offset:2176
    ds_read_b128 v[152:155], v11
    ds_read_b64_tr_b16 v[156:157], v14 offset:3072
    ds_read_b64_tr_b16 v[158:159], v14 offset:3200
    s_cbranch_scc0 L_h_vproj
    s_waitcnt lgkmcnt(9)
    v_mfma_f32_16x16x32_bf16 v[40:43], v[132:135], v[128:131], 0
    s_waitcnt lgkmcnt(6)
    v_mfma_f32_16x16x32_bf16 v[40:43], v[140:143], v[136:139], v[40:43]
    s_waitcnt lgkmcnt(3)
    v_mfma_f32_16x16x32_bf16 v[40:43], v[148:151], v[144:147], v[40:43]
    s_waitcnt lgkmcnt(0)
    v_mfma_f32_16x16x32_bf16 v[40:43], v[156:159], v[152:155], v[40:43]
    s_branch L_h_kvdone
L_h_vproj:
    s_waitcnt lgkmcnt(9)
    v_mfma_f32_16x16x32_bf16 v[40:43], v[128:131], v[132:135], 0
    s_waitcnt lgkmcnt(6)
    v_mfma_f32_16x16x32_bf16 v[40:43], v[136:139], v[140:143], v[40:43]
    s_waitcnt lgkmcnt(3)
    v_mfma_f32_16x16x32_bf16 v[40:43], v[144:147], v[148:151], v[40:43]
    s_waitcnt lgkmcnt(0)
    v_mfma_f32_16x16x32_bf16 v[40:43], v[152:155], v[156:159], v[40:43]
L_h_kvdone:
    s_cmp_eq_u32 s15, 0
    s_cbranch_scc1 L_h_pub
    s_nop 5
    ds_write_b128 v15, v[40:43]
    s_waitcnt lgkmcnt(0)
    s_barrier
    s_branch L_h_common
L_h_pub:
    s_barrier
    ds_read_b128 v[44:47], v15 offset:1024
    ds_read_b128 v[48:51], v15 offset:2048
    ds_read_b128 v[52:55], v15 offset:3072
    s_nop 1
    s_waitcnt lgkmcnt(0)
    v_pk_add_f32 v[40:41], v[40:41], v[44:45]
    v_pk_add_f32 v[42:43], v[42:43], v[46:47]
    v_pk_add_f32 v[48:49], v[48:49], v[52:53]
    v_pk_add_f32 v[50:51], v[50:51], v[54:55]
    v_pk_add_f32 v[40:41], v[40:41], v[48:49]
    v_pk_add_f32 v[42:43], v[42:43], v[50:51]
    v_cvt_pk_bf16_f32 v40, v40, v41
    v_cvt_pk_bf16_f32 v41, v42, v43
    buffer_store_dwordx2 v[40:41], v16, s[52:55], s50 offen sc1
    s_branch L_h_common
L_attn:
    s_getpc_b64 s[68:69]
L_pc:
    s_sub_u32 s68, s68, L_pc - concat_heads__grouped_kv_mqa__ssm_conv_s5__prompt_kernel
    s_subb_u32 s69, s69, 0
    s_and_b32 s11, s10, 31
    s_lshl2_add_u32 s11, s11, s15
    s_mul_i32 s11, s11, 256
    v_lshlrev_b32 v32, 7, v0
    v_min_u32 v32, 128, v32
    v_add_u32 v32, s11, v32
    v_min_u32 v32, L_slow - concat_heads__grouped_kv_mqa__ssm_conv_s5__prompt_kernel, v32
    s_cmp_ge_u32 s11, L_slow - concat_heads__grouped_kv_mqa__ssm_conv_s5__prompt_kernel
    s_cbranch_scc1 L_nocpf
    s_mov_b64 exec, 3
    global_load_dword v33, v32, s[68:69]
    s_mov_b64 exec, -1
L_nocpf:
    v_mov_b32 v2, 0
    v_mov_b32 v3, 0
    v_mov_b32 v4, 0
    v_mov_b32 v5, 0
    v_add_u32 v7, 158720, v6
    ds_write_b128 v7, v[2:5]
    ds_write_b128 v7, v[2:5] offset:1024
    v_lshl_add_u32 v14, s15, 2, v12
    v_xor_b32 v15, v13, v14
    v_lshlrev_b32 v15, 4, v15
    v_lshl_add_u32 v16, v14, 10, v15
    v_lshrrev_b32 v20, 3, v0
    v_and_b32 v21, 7, v0
    v_lshrrev_b32 v22, 2, v0
    v_and_b32 v22, 4, v22
    v_xor_b32 v21, v21, v22
    v_lshlrev_b32 v21, 4, v21
    v_lshl_add_u32 v17, v20, 10, v21
    s_lshl_b32 s9, s6, 7
    s_lshl_b32 s10, s15, 15
    s_add_u32 s9, s9, s10
    s_lshl_b32 s10, s15, 12
    s_lshl_b32 s13, s5, 16
    s_lshl_b32 s50, s15, 10
    s_add_u32 s11, s70, 1
    s_and_b32 s11, s11, 3
    s_lshl_b32 s12, s11, 14
    s_add_u32 s96, s12, s13
    s_lshl_b32 s12, s11, 12
    s_add_u32 s99, s12, s50
    s_add_u32 s11, s70, 2
    s_and_b32 s11, s11, 3
    s_lshl_b32 s12, s11, 14
    s_add_u32 s97, s12, s13
    s_lshl_b32 s12, s11, 12
    s_add_u32 s100, s12, s50
    s_add_u32 s11, s70, 3
    s_and_b32 s11, s11, 3
    s_lshl_b32 s12, s11, 14
    s_add_u32 s98, s12, s13
    s_lshl_b32 s12, s11, 12
    s_add_u32 s101, s12, s50
    s_mov_b32 s62, 524288
    v_mov_b32 v12, 159744
    v_mov_b32 v13, 1
    s_waitcnt lgkmcnt(0)
    s_mov_b32 s56, s16
    s_and_b32 s57, s17, 0xffff
    s_mov_b32 s60, s18
    s_and_b32 s61, s19, 0xffff
    s_barrier
    s_and_b32 s11, s5, 3
    s_lshl2_add_u32 s11, s11, s15
    s_lshl_b32 s11, s11, 15
    s_lshl_b32 s12, s6, 7
    s_add_u32 s11, s11, s12
    v_and_b32 v20, 31, v0
    v_lshlrev_b32 v20, 10, v20
    s_mov_b32 exec_hi, 0
    buffer_load_dword v34, v20, s[60:63], s11 offen
    s_mov_b64 exec, -1
    s_mov_b32 s52, s48
    s_and_b32 s53, s49, 0xffff
    s_mov_b32 s54, 16777216
    s_mov_b32 s55, 0x20000
    s_mov_b32 s73, 0
    s_mov_b32 s78, 0x21800000
    s_mov_b32 s79, 0x5d800000
    v_and_b32 v24, 27, v0
    v_cmp_eq_u32 vcc, 16, v24
    v_mov_b32 v25, 0x3f803f80
    s_nop 0
    v_cndmask_b32 v24, 0, v25, vcc
    v_mov_b32 v25, v24
    v_mov_b64 v[68:69], v[24:25]
    v_mov_b64 v[70:71], v[24:25]
    v_mov_b64 v[72:73], v[24:25]
    v_mov_b64 v[74:75], v[24:25]
    v_mov_b64 v[80:81], v[24:25]
    v_mov_b64 v[82:83], v[24:25]
    v_mov_b64 v[84:85], v[24:25]
    v_mov_b64 v[86:87], v[24:25]
    v_mov_b64 v[92:93], v[24:25]
    v_mov_b64 v[94:95], v[24:25]
    v_mov_b64 v[96:97], v[24:25]
    v_mov_b64 v[98:99], v[24:25]
    v_mov_b64 v[104:105], v[24:25]
    v_mov_b64 v[106:107], v[24:25]
    v_mov_b64 v[108:109], v[24:25]
    v_mov_b64 v[110:111], v[24:25]
    v_mov_b64 v[116:117], v[24:25]
    v_mov_b64 v[118:119], v[24:25]
    v_mov_b64 v[120:121], v[24:25]
    v_mov_b64 v[122:123], v[24:25]
    v_mov_b64 v[128:129], v[24:25]
    v_mov_b64 v[130:131], v[24:25]
    v_mov_b64 v[132:133], v[24:25]
    v_mov_b64 v[134:135], v[24:25]
    v_mov_b64 v[140:141], v[24:25]
    v_mov_b64 v[142:143], v[24:25]
    v_mov_b64 v[144:145], v[24:25]
    v_mov_b64 v[146:147], v[24:25]
    v_mov_b64 v[152:153], v[24:25]
    v_mov_b64 v[154:155], v[24:25]
    v_mov_b64 v[156:157], v[24:25]
    v_mov_b64 v[158:159], v[24:25]
    v_mov_b64 v[164:165], v[24:25]
    v_mov_b64 v[166:167], v[24:25]
    v_mov_b64 v[168:169], v[24:25]
    v_mov_b64 v[170:171], v[24:25]
    v_mov_b64 v[176:177], v[24:25]
    v_mov_b64 v[178:179], v[24:25]
    v_mov_b64 v[180:181], v[24:25]
    v_mov_b64 v[182:183], v[24:25]
    v_mov_b64 v[188:189], v[24:25]
    v_mov_b64 v[190:191], v[24:25]
    v_mov_b64 v[192:193], v[24:25]
    v_mov_b64 v[194:195], v[24:25]
    v_mov_b64 v[200:201], v[24:25]
    v_mov_b64 v[202:203], v[24:25]
    v_mov_b64 v[204:205], v[24:25]
    v_mov_b64 v[206:207], v[24:25]
    v_mov_b64 v[212:213], v[24:25]
    v_mov_b64 v[214:215], v[24:25]
    v_mov_b64 v[216:217], v[24:25]
    v_mov_b64 v[218:219], v[24:25]
    v_mov_b64 v[224:225], v[24:25]
    v_mov_b64 v[226:227], v[24:25]
    v_mov_b64 v[228:229], v[24:25]
    v_mov_b64 v[230:231], v[24:25]
    v_mov_b64 v[236:237], v[24:25]
    v_mov_b64 v[238:239], v[24:25]
    v_mov_b64 v[240:241], v[24:25]
    v_mov_b64 v[242:243], v[24:25]
    v_mov_b64 v[248:249], v[24:25]
    v_mov_b64 v[250:251], v[24:25]
    v_mov_b64 v[252:253], v[24:25]
    v_mov_b64 v[254:255], v[24:25]
    v_mov_b32 v14, v6
    v_lshrrev_b32 v24, 5, v0
    v_and_b32 v25, 15, v0
    v_lshl_add_u32 v15, v24, 4, v25
    v_lshlrev_b32 v15, 4, v15
    v_mov_b32 v1, 0xdddddddd
    s_lshl_b32 s11, s15, 11
    v_add_u32 v4, s11, v14
    s_lshl_b32 s11, s15, 2
    s_add_u32 s12, s11, 8192
    v_add_u32 v5, s12, v14
    s_add_u32 s12, s11, 158720
    v_add_u32 v7, s12, v14
    v_add_u32 v6, 150528, v14
    v_lshlrev_b32 v23, 6, v0
    s_barrier
    ds_read_b32 v20, v12 offset:28
    s_add_u32 s12, s72, 0
    s_and_b32 s12, s12, 3
    s_lshl_b32 s13, s12, 8
    s_lshl_b32 s12, s12, 17
    s_add_u32 s12, s12, s9
    s_add_u32 m0, s99, 0
    s_add_u32 s11, s96, s13
    buffer_load_dwordx4 v16, s[56:59], s11 offen lds
    s_add_u32 m0, s100, 0
    s_add_u32 s11, s97, s13
    buffer_load_dwordx4 v16, s[56:59], s11 offen lds
    s_add_u32 m0, s101, 0
    s_add_u32 s11, s98, s13
    buffer_load_dwordx4 v16, s[56:59], s11 offen lds
    s_add_u32 m0, s10, 65536
    s_add_u32 s11, s12, 0
    buffer_load_dwordx4 v17, s[60:63], s11 offen lds
    s_add_u32 m0, s10, 66560
    s_add_u32 s11, s12, 8192
    buffer_load_dwordx4 v17, s[60:63], s11 offen lds
    s_add_u32 m0, s10, 67584
    s_add_u32 s11, s12, 16384
    buffer_load_dwordx4 v17, s[60:63], s11 offen lds
    s_add_u32 m0, s10, 68608
    s_add_u32 s11, s12, 24576
    buffer_load_dwordx4 v17, s[60:63], s11 offen lds
    s_add_u32 s12, s72, 1
    s_and_b32 s12, s12, 3
    s_lshl_b32 s13, s12, 8
    s_lshl_b32 s12, s12, 17
    s_add_u32 s12, s12, s9
    s_add_u32 m0, s99, 16384
    s_add_u32 s11, s96, s13
    buffer_load_dwordx4 v16, s[56:59], s11 offen lds
    s_add_u32 m0, s100, 16384
    s_add_u32 s11, s97, s13
    buffer_load_dwordx4 v16, s[56:59], s11 offen lds
    s_add_u32 m0, s101, 16384
    s_add_u32 s11, s98, s13
    buffer_load_dwordx4 v16, s[56:59], s11 offen lds
    s_add_u32 m0, s10, 81920
    s_add_u32 s11, s12, 0
    buffer_load_dwordx4 v17, s[60:63], s11 offen lds
    s_add_u32 m0, s10, 82944
    s_add_u32 s11, s12, 8192
    buffer_load_dwordx4 v17, s[60:63], s11 offen lds
    s_add_u32 m0, s10, 83968
    s_add_u32 s11, s12, 16384
    buffer_load_dwordx4 v17, s[60:63], s11 offen lds
    s_add_u32 m0, s10, 84992
    s_add_u32 s11, s12, 24576
    buffer_load_dwordx4 v17, s[60:63], s11 offen lds
    s_add_u32 s12, s72, 2
    s_and_b32 s12, s12, 3
    s_lshl_b32 s13, s12, 8
    s_lshl_b32 s12, s12, 17
    s_add_u32 s12, s12, s9
    s_add_u32 m0, s99, 32768
    s_add_u32 s11, s96, s13
    buffer_load_dwordx4 v16, s[56:59], s11 offen lds
    s_add_u32 m0, s100, 32768
    s_add_u32 s11, s97, s13
    buffer_load_dwordx4 v16, s[56:59], s11 offen lds
    s_add_u32 m0, s101, 32768
    s_add_u32 s11, s98, s13
    buffer_load_dwordx4 v16, s[56:59], s11 offen lds
    s_add_u32 m0, s10, 98304
    s_add_u32 s11, s12, 0
    buffer_load_dwordx4 v17, s[60:63], s11 offen lds
    s_add_u32 m0, s10, 99328
    s_add_u32 s11, s12, 8192
    buffer_load_dwordx4 v17, s[60:63], s11 offen lds
    s_add_u32 m0, s10, 100352
    s_add_u32 s11, s12, 16384
    buffer_load_dwordx4 v17, s[60:63], s11 offen lds
    s_add_u32 m0, s10, 101376
    s_add_u32 s11, s12, 24576
    buffer_load_dwordx4 v17, s[60:63], s11 offen lds
    s_add_u32 s12, s72, 3
    s_and_b32 s12, s12, 3
    s_lshl_b32 s13, s12, 8
    s_lshl_b32 s12, s12, 17
    s_add_u32 s12, s12, s9
    s_add_u32 m0, s99, 49152
    s_add_u32 s11, s96, s13
    buffer_load_dwordx4 v16, s[56:59], s11 offen lds
    s_add_u32 m0, s100, 49152
    s_add_u32 s11, s97, s13
    buffer_load_dwordx4 v16, s[56:59], s11 offen lds
    s_add_u32 m0, s101, 49152
    s_add_u32 s11, s98, s13
    buffer_load_dwordx4 v16, s[56:59], s11 offen lds
    s_add_u32 m0, s10, 114688
    s_add_u32 s11, s12, 0
    buffer_load_dwordx4 v17, s[60:63], s11 offen lds
    s_add_u32 m0, s10, 115712
    s_add_u32 s11, s12, 8192
    buffer_load_dwordx4 v17, s[60:63], s11 offen lds
    s_add_u32 m0, s10, 116736
    s_add_u32 s11, s12, 16384
    buffer_load_dwordx4 v17, s[60:63], s11 offen lds
    s_add_u32 m0, s10, 117760
    s_add_u32 s11, s12, 24576
    buffer_load_dwordx4 v17, s[60:63], s11 offen lds
    s_waitcnt vmcnt(14) lgkmcnt(0)
    s_barrier
    v_readfirstlane_b32 s4, v20
    s_sub_u32 s72, 7, s15
    s_and_b32 s9, s72, 1
    s_lshl_b32 s10, s5, 1
    s_add_u32 s9, s9, s10
    s_lshl_b32 s9, s9, 2
    s_lshr_b32 s10, s72, 1
    s_add_u32 s9, s9, s10
    s_lshl_b32 s9, s9, 3
    s_add_u32 s9, s9, s6
    s_lshl_b32 s10, s9, 10
    s_add_u32 s10, s10, 1048576
    s_lshl_b32 s9, s9, 7
    s_add_u32 s9, s9, 524288
    s_mov_b32 s0, s9
    s_mov_b32 s1, s10
    s_mul_i32 s11, s72, 9216
    s_lshr_b32 s13, s15, 1
    s_lshl1_add_u32 s96, s5, s13
    s_lshl_b32 s97, s96, 12
    s_add_u32 s97, s97, 526336
    s_mov_b32 s60, s44
    s_and_b32 s61, s45, 0xffff
    s_mov_b32 s62, 8388608
    s_mov_b32 s63, 0x20000
    s_and_b32 s9, s15, 1
    s_lshl1_add_u32 s9, s6, s9
    s_lshl_b32 s9, s9, 7
    s_lshl_b32 s12, s96, 17
    s_add_u32 s12, s12, s9
    s_lshl_b32 s51, s96, 15
    s_add_u32 s51, s51, 1064960
    s_mul_i32 s13, s15, 9216
    s_lshl_b32 s50, s15, 9
    s_add_u32 s50, s50, 160832
    s_lshl_b32 s9, s15, 12
    s_add_u32 s9, s9, 4096
    s_waitcnt vmcnt(7)
    s_barrier
    s_waitcnt vmcnt(0)
    buffer_load_dword v22, v23, s[52:55], s9 offen sc1
    s_barrier
    s_branch L_a2
L_h_common:
    s_mov_b32 s73, 0
    v_and_b32 v17, 31, v0
    v_lshrrev_b32 v18, 5, v0
    s_lshr_b32 s9, s15, 1
    s_lshl_b32 s9, s9, 13
    v_xor_b32 v34, v13, v18
    v_lshlrev_b32 v34, 4, v34
    v_lshl_add_u32 v34, v17, 8, v34
    v_add_u32 v48, s9, v34
    v_xor_b32 v49, 32, v48
    v_xor_b32 v50, 64, v48
    v_xor_b32 v51, 96, v48
    v_xor_b32 v52, 128, v48
    v_xor_b32 v53, 160, v48
    v_xor_b32 v54, 192, v48
    v_xor_b32 v55, 224, v48
    v_bfe_u32 v34, v0, 2, 2
    v_bfe_u32 v35, v0, 4, 1
    v_bfe_u32 v36, v0, 1, 1
    v_lshl_add_u32 v35, v35, 1, v36
    s_and_b32 s9, s15, 1
    s_lshl_b32 s9, s9, 2
    v_add_u32 v35, s9, v35
    v_bfe_u32 v36, v0, 3, 1
    v_lshlrev_b32 v36, 2, v36
    v_xor_b32 v35, v35, v36
    v_lshlrev_b32 v35, 4, v35
    v_lshl_add_u32 v35, v34, 7, v35
    v_and_b32 v36, 1, v0
    v_lshl_add_u32 v35, v36, 3, v35
    v_lshrrev_b32 v36, 5, v0
    v_lshl_add_u32 v35, v36, 9, v35
    v_add_u32 v4, 73728, v35
    v_lshl_add_u32 v56, v18, 9, v4
    v_add_u32 v56, 4294959104, v56
    s_and_b32 s10, s15, 1
    s_lshl_b32 s10, s10, 12
    s_lshr_b32 s11, s15, 1
    s_lshl_b32 s11, s11, 10
    s_add_u32 s10, s10, s11
    s_add_u32 s10, s10, 150528
    v_add_u32 v57, s10, v6
    v_mov_b32 v58, 0x3eb8aa3b
    v_mov_b32 v59, v58
    s_mov_b32 s56, s26
    s_and_b32 s57, s27, 0xffff
    s_mov_b32 s60, s32
    s_and_b32 s61, s33, 0xffff
    s_mov_b32 s62, 524288
    s_mov_b32 s63, 0x20000
    s_mov_b32 s64, s34
    s_and_b32 s65, s35, 0xffff
    s_mov_b32 s66, 524288
    s_mov_b32 s67, 0x20000
    s_mov_b32 s78, 0x21800000
    s_mov_b32 s79, 0x5d800000
    s_lshl_b32 s9, s7, 17
    s_lshl_b32 s10, s15, 15
    s_add_u32 s12, s9, s10
    s_lshr_b32 s9, s15, 1
    s_lshl1_add_u32 s96, s5, s9
    s_mov_b32 s101, s96
    s_and_b32 s9, s15, 1
    s_lshl1_add_u32 s97, s100, s9
    s_lshl_b32 s13, s101, 15
    s_lshl_b32 s11, s97, 6
    s_add_u32 s13, s13, s11
    v_lshrrev_b32 v34, 3, v0
    v_and_b32 v35, 7, v0
    v_lshrrev_b32 v36, 2, v0
    v_and_b32 v36, 4, v36
    v_xor_b32 v35, v35, v36
    v_lshlrev_b32 v35, 4, v35
    v_lshl_add_u32 v7, v34, 10, v35
    v_lshrrev_b32 v36, 2, v0
    v_and_b32 v34, 3, v36
    v_bfe_u32 v35, v36, 2, 1
    v_lshl_add_u32 v34, v35, 4, v34
    v_lshrrev_b32 v35, 3, v36
    v_lshl_add_u32 v34, v35, 2, v34
    v_and_b32 v37, 3, v0
    v_lshlrev_b32 v35, 4, v37
    v_lshl_add_u32 v8, v34, 10, v35
    v_add_u32 v9, 8192, v8
    v_mul_u32_u24 v5, 1040, v17
    v_lshl_add_u32 v5, v18, 4, v5
    v_add_u32 v5, 73728, v5
    s_lshl_b32 s10, s15, 11
    s_add_u32 s10, s10, 140288
    v_xor_b32 v34, v12, v37
    v_lshlrev_b32 v34, 4, v34
    v_lshl_add_u32 v34, v36, 6, v34
    v_add_u32 v10, s10, v34
    v_bfe_u32 v34, v0, 2, 2
    v_xor_b32 v35, v34, v18
    v_lshlrev_b32 v35, 4, v35
    v_lshl_add_u32 v35, v17, 6, v35
    v_add_u32 v11, s10, v35
    v_xor_b32 v12, 32, v11
    v_lshl_add_u32 v34, v18, 3, v34
    v_lshlrev_b32 v34, 6, v34
    v_bfe_u32 v35, v0, 4, 1
    v_lshl_add_u32 v34, v35, 5, v34
    v_lshl_add_u32 v34, v37, 3, v34
    v_add_u32 v19, s10, v34
    v_lshlrev_b32 v34, 6, v17
    v_lshl_add_u32 v34, v18, 5, v34
    v_add_u32 v16, s10, v34
    v_lshlrev_b32 v38, 4, v18
    v_lshl_add_u32 v29, v17, 10, v38
    v_lshlrev_b32 v14, 4, v17
    s_waitcnt vmcnt(1)
    s_cmp_eq_u32 s15, 0
    s_cbranch_scc1 L_h_pw
    s_waitcnt vmcnt(0)
L_h_pw:
    v_lshlrev_b32 v60, 16, v60
    v_lshlrev_b32 v61, 16, v61
    v_lshlrev_b32 v62, 16, v62
    v_mul_f32 v62, 0x3fb8aa3b, v62
    v_exp_f32 v62, v62
    s_nop 0
    v_cvt_pk_bf16_f32 v62, v62, v62
    v_and_b32 v62, 0xffff0000, v62
    v_mul_f32 v64, v62, v60
    v_mul_f32 v65, v62, v61
    v_mul_f32 v64, 0x3fb8aa3b, v64
    v_mul_f32 v65, 0x3e22f983, v65
    v_exp_f32 v64, v64
    v_rndne_f32 v66, v65
    v_sub_f32 v65, v65, v66
    v_cos_f32 v66, v65
    v_sin_f32 v67, v65
    v_mul_f32 v68, v60, v60
    v_fma_f32 v68, v61, v61, v68
    v_mul_f32 v20, v64, v66
    v_mul_f32 v21, v64, v67
    v_rcp_f32 v68, v68
    v_add_f32 v66, -1.0, v20
    v_add_f32 v68, v68, v68
    v_mul_f32 v64, v66, v60
    v_fma_f32 v64, v21, v61, v64
    v_mul_f32 v65, v21, v60
    v_fma_f32 v65, -v66, v61, v65
    v_mul_f32 v26, v64, v68
    v_mul_f32 v27, v65, v68
    v_pk_mul_f32 v[70:71], v[20:21], v[20:21] op_sel:[0,0] op_sel_hi:[0,1]
    v_pk_fma_f32 v[70:71], v[20:21], v[20:21], v[70:71] op_sel:[1,1,0] op_sel_hi:[1,0,1] neg_lo:[1,0,0]
    v_pk_mul_f32 v[72:73], v[70:71], v[70:71] op_sel:[0,0] op_sel_hi:[0,1]
    v_pk_fma_f32 v[72:73], v[70:71], v[70:71], v[72:73] op_sel:[1,1,0] op_sel_hi:[1,0,1] neg_lo:[1,0,0]
    v_pk_mul_f32 v[24:25], v[72:73], v[72:73] op_sel:[0,0] op_sel_hi:[0,1]
    v_pk_fma_f32 v[24:25], v[72:73], v[72:73], v[24:25] op_sel:[1,1,0] op_sel_hi:[1,0,1] neg_lo:[1,0,0]
    v_pk_mul_f32 v[22:23], v[24:25], v[24:25] op_sel:[0,0] op_sel_hi:[0,1]
    v_pk_fma_f32 v[22:23], v[24:25], v[24:25], v[22:23] op_sel:[1,1,0] op_sel_hi:[1,0,1] neg_lo:[1,0,0]
    v_and_b32 v64, 1, v0
    v_lshlrev_b32 v64, 4, v64
    v_lshlrev_b32 v63, v64, v63
    v_lshrrev_b32 v64, 1, v17
    v_lshlrev_b32 v65, 2, v18
    v_sub_u32 v64, v64, v65
    v_cmp_eq_u32 s[68:69], 0, v64
    v_cmp_eq_u32 vcc, 1, v64
    s_nop 0
    v_cndmask_b32 v104, 0, v63, s[68:69]
    v_cndmask_b32 v105, 0, v63, vcc
    v_cmp_eq_u32 s[68:69], 2, v64
    v_cmp_eq_u32 vcc, 3, v64
    s_nop 0
    v_cndmask_b32 v106, 0, v63, s[68:69]
    v_cndmask_b32 v107, 0, v63, vcc
    v_cmp_eq_u32 s[68:69], 8, v64
    v_cmp_eq_u32 vcc, 9, v64
    s_nop 0
    v_cndmask_b32 v108, 0, v63, s[68:69]
    v_cndmask_b32 v109, 0, v63, vcc
    v_cmp_eq_u32 s[68:69], 10, v64
    v_cmp_eq_u32 vcc, 11, v64
    s_nop 0
    v_cndmask_b32 v110, 0, v63, s[68:69]
    v_cndmask_b32 v111, 0, v63, vcc
    s_waitcnt vmcnt(0)
    s_cmp_eq_u32 s15, 0
    s_cbranch_scc0 L_h_nopub
    s_getreg_b32 s9, hwreg(HW_REG_XCC_ID, 0, 4)
    s_xor_b32 s9, s9, s4
    v_mov_b32 v34, 0
    v_mov_b32 v35, s9
    s_mov_b64 exec, 1
    buffer_store_dword v35, v34, s[52:55], s51 offen sc1
    s_mov_b64 exec, -1
L_h_nopub:
    s_mov_b32 s68, 0
    s_mov_b32 s69, -1
    v_pk_mul_f32 v[68:69], v[22:23], v[22:23] op_sel:[0,0] op_sel_hi:[0,1]
    v_pk_fma_f32 v[68:69], v[22:23], v[22:23], v[68:69] op_sel:[1,1,0] op_sel_hi:[1,0,1] neg_lo:[1,0,0]
    v_pk_mul_f32 v[70:71], v[68:69], v[68:69] op_sel:[0,0] op_sel_hi:[0,1]
    v_pk_fma_f32 v[70:71], v[68:69], v[68:69], v[70:71] op_sel:[1,1,0] op_sel_hi:[1,0,1] neg_lo:[1,0,0]
    v_pk_mul_f32 v[72:73], v[70:71], v[70:71] op_sel:[0,0] op_sel_hi:[0,1]
    v_pk_fma_f32 v[72:73], v[70:71], v[70:71], v[72:73] op_sel:[1,1,0] op_sel_hi:[1,0,1] neg_lo:[1,0,0]
    v_pk_mul_f32 v[74:75], v[72:73], v[72:73] op_sel:[0,0] op_sel_hi:[0,1]
    v_pk_fma_f32 v[74:75], v[72:73], v[72:73], v[74:75] op_sel:[1,1,0] op_sel_hi:[1,0,1] neg_lo:[1,0,0]
    v_pk_mul_f32 v[76:77], v[74:75], v[74:75] op_sel:[0,0] op_sel_hi:[0,1]
    v_pk_fma_f32 v[76:77], v[74:75], v[74:75], v[76:77] op_sel:[1,1,0] op_sel_hi:[1,0,1] neg_lo:[1,0,0]
    v_pk_mul_f32 v[78:79], v[76:77], v[76:77] op_sel:[0,0] op_sel_hi:[0,1]
    v_pk_fma_f32 v[78:79], v[76:77], v[76:77], v[78:79] op_sel:[1,1,0] op_sel_hi:[1,0,1] neg_lo:[1,0,0]
    v_cndmask_b32 v96, 1.0, v22, s[68:69]
    v_cndmask_b32 v97, 0, v23, s[68:69]
    s_bitcmp1_b32 s15, 0
    s_cbranch_scc0 L_ps7
    v_pk_mul_f32 v[66:67], v[96:97], v[68:69] op_sel:[0,0] op_sel_hi:[0,1]
    v_pk_fma_f32 v[66:67], v[96:97], v[68:69], v[66:67] op_sel:[1,1,0] op_sel_hi:[1,0,1] neg_lo:[1,0,0]
    v_mov_b64 v[96:97], v[66:67]
L_ps7:
    s_bitcmp1_b32 s15, 1
    s_cbranch_scc0 L_ps8
    v_pk_mul_f32 v[66:67], v[96:97], v[70:71] op_sel:[0,0] op_sel_hi:[0,1]
    v_pk_fma_f32 v[66:67], v[96:97], v[70:71], v[66:67] op_sel:[1,1,0] op_sel_hi:[1,0,1] neg_lo:[1,0,0]
    v_mov_b64 v[96:97], v[66:67]
L_ps8:
    v_cndmask_b32 v98, 1.0, v74, s[68:69]
    v_cndmask_b32 v99, 0, v75, s[68:69]
    s_bitcmp1_b32 s15, 0
    s_cbranch_scc0 L_ps9
    v_pk_mul_f32 v[66:67], v[98:99], v[76:77] op_sel:[0,0] op_sel_hi:[0,1]
    v_pk_fma_f32 v[66:67], v[98:99], v[76:77], v[66:67] op_sel:[1,1,0] op_sel_hi:[1,0,1] neg_lo:[1,0,0]
    v_mov_b64 v[98:99], v[66:67]
L_ps9:
    s_bitcmp1_b32 s15, 1
    s_cbranch_scc0 L_ps10
    v_pk_mul_f32 v[66:67], v[98:99], v[78:79] op_sel:[0,0] op_sel_hi:[0,1]
    v_pk_fma_f32 v[66:67], v[98:99], v[78:79], v[66:67] op_sel:[1,1,0] op_sel_hi:[1,0,1] neg_lo:[1,0,0]
    v_mov_b64 v[98:99], v[66:67]
L_ps10:
    v_pk_mul_f32 v[100:101], v[98:99], v[72:73] op_sel:[0,0] op_sel_hi:[0,1]
    v_pk_fma_f32 v[100:101], v[98:99], v[72:73], v[100:101] op_sel:[1,1,0] op_sel_hi:[1,0,1] neg_lo:[1,0,0]
    s_lshl_b32 s9, s15, 2
    s_sub_u32 s9, s7, s9
    s_sub_u32 s9, s9, 1
    v_lshlrev_b32 v30, 1, v18
    v_sub_u32 v102, s9, v30
    v_add_u32 v103, -1, v102
    v_mov_b32 v30, 0
    v_cmp_le_i32 vcc, 0, v102
    s_nop 1
    v_cndmask_b32 v102, v30, v102, vcc
    v_cndmask_b32 v98, 0, v98, vcc
    v_cndmask_b32 v99, 0, v99, vcc
    v_lshl_add_u32 v102, v102, 9, v14
    v_cmp_le_i32 vcc, 0, v103
    s_nop 1
    v_cndmask_b32 v103, v30, v103, vcc
    v_cndmask_b32 v100, 0, v100, vcc
    v_cndmask_b32 v101, 0, v101, vcc
    v_lshl_add_u32 v103, v103, 9, v14
    s_barrier
    ds_read_b64_tr_b16 v[128:129], v56 offset:0
    ds_read_b64_tr_b16 v[130:131], v56 offset:512
    ds_read_b128 v[132:135], v48 offset:0
    ds_read_b64_tr_b16 v[136:137], v56 offset:2048
    ds_read_b64_tr_b16 v[138:139], v56 offset:2560
    ds_read_b128 v[140:143], v49 offset:0
    ds_read_b64_tr_b16 v[144:145], v56 offset:4096
    ds_read_b64_tr_b16 v[146:147], v56 offset:4608
    ds_read_b128 v[148:151], v50 offset:0
    ds_read_b64_tr_b16 v[152:153], v56 offset:6144
    ds_read_b64_tr_b16 v[154:155], v56 offset:6656
    ds_read_b128 v[156:159], v51 offset:0
    ds_read_b64_tr_b16 v[160:161], v56 offset:8192
    ds_read_b64_tr_b16 v[162:163], v56 offset:8704
    ds_read_b128 v[164:167], v52 offset:0
    s_waitcnt lgkmcnt(12)
    v_mfma_f32_32x32x16_bf16 v[32:47], v[128:131], v[132:135], 0
    ds_read_b64_tr_b16 v[168:169], v56 offset:10240
    ds_read_b64_tr_b16 v[170:171], v56 offset:10752
    ds_read_b128 v[172:175], v53 offset:0
    s_waitcnt lgkmcnt(12)
    v_mfma_f32_32x32x16_bf16 v[32:47], v[136:139], v[140:143], v[32:47]
    ds_read_b64_tr_b16 v[176:177], v56 offset:12288
    ds_read_b64_tr_b16 v[178:179], v56 offset:12800
    ds_read_b128 v[180:183], v54 offset:0
    s_waitcnt lgkmcnt(12)
    v_mfma_f32_32x32x16_bf16 v[32:47], v[144:147], v[148:151], v[32:47]
    ds_read_b64_tr_b16 v[184:185], v56 offset:14336
    ds_read_b64_tr_b16 v[186:187], v56 offset:14848
    ds_read_b128 v[188:191], v55 offset:0
    s_waitcnt lgkmcnt(12)
    v_mfma_f32_32x32x16_bf16 v[32:47], v[152:155], v[156:159], v[32:47]
    ds_read_b64_tr_b16 v[128:129], v56 offset:16384
    ds_read_b64_tr_b16 v[130:131], v56 offset:16896
    ds_read_b128 v[132:135], v48 offset:16384
    s_waitcnt lgkmcnt(12)
    v_mfma_f32_32x32x16_bf16 v[32:47], v[160:163], v[164:167], v[32:47]
    ds_read_b64_tr_b16 v[136:137], v56 offset:18432
    ds_read_b64_tr_b16 v[138:139], v56 offset:18944
    ds_read_b128 v[140:143], v49 offset:16384
    s_waitcnt lgkmcnt(12)
    v_mfma_f32_32x32x16_bf16 v[32:47], v[168:171], v[172:175], v[32:47]
    ds_read_b64_tr_b16 v[144:145], v56 offset:20480
    ds_read_b64_tr_b16 v[146:147], v56 offset:20992
    ds_read_b128 v[148:151], v50 offset:16384
    s_waitcnt lgkmcnt(12)
    v_mfma_f32_32x32x16_bf16 v[32:47], v[176:179], v[180:183], v[32:47]
    ds_read_b64_tr_b16 v[152:153], v56 offset:22528
    ds_read_b64_tr_b16 v[154:155], v56 offset:23040
    ds_read_b128 v[156:159], v51 offset:16384
    s_waitcnt lgkmcnt(12)
    v_mfma_f32_32x32x16_bf16 v[32:47], v[184:187], v[188:191], v[32:47]
    ds_read_b64_tr_b16 v[160:161], v56 offset:24576
    ds_read_b64_tr_b16 v[162:163], v56 offset:25088
    ds_read_b128 v[164:167], v52 offset:16384
    s_waitcnt lgkmcnt(12)
    v_mfma_f32_32x32x16_bf16 v[32:47], v[128:131], v[132:135], v[32:47]
    ds_read_b64_tr_b16 v[168:169], v56 offset:26624
    ds_read_b64_tr_b16 v[170:171], v56 offset:27136
    ds_read_b128 v[172:175], v53 offset:16384
    s_waitcnt lgkmcnt(12)
    v_mfma_f32_32x32x16_bf16 v[32:47], v[136:139], v[140:143], v[32:47]
    ds_read_b64_tr_b16 v[176:177], v56 offset:28672
    ds_read_b64_tr_b16 v[178:179], v56 offset:29184
    ds_read_b128 v[180:183], v54 offset:16384
    s_waitcnt lgkmcnt(12)
    v_mfma_f32_32x32x16_bf16 v[32:47], v[144:147], v[148:151], v[32:47]
    ds_read_b64_tr_b16 v[184:185], v56 offset:30720
    ds_read_b64_tr_b16 v[186:187], v56 offset:31232
    ds_read_b128 v[188:191], v55 offset:16384
    s_waitcnt lgkmcnt(12)
    v_mfma_f32_32x32x16_bf16 v[32:47], v[152:155], v[156:159], v[32:47]
    s_barrier
    ds_read_b64_tr_b16 v[128:129], v56 offset:32768
    ds_read_b64_tr_b16 v[130:131], v56 offset:33280
    ds_read_b128 v[132:135], v48 offset:32768
    s_waitcnt lgkmcnt(12)
    v_mfma_f32_32x32x16_bf16 v[32:47], v[160:163], v[164:167], v[32:47]
    ds_read_b64_tr_b16 v[136:137], v56 offset:34816
    ds_read_b64_tr_b16 v[138:139], v56 offset:35328
    ds_read_b128 v[140:143], v49 offset:32768
    s_waitcnt lgkmcnt(12)
    v_mfma_f32_32x32x16_bf16 v[32:47], v[168:171], v[172:175], v[32:47]
    ds_read_b64_tr_b16 v[144:145], v56 offset:36864
    ds_read_b64_tr_b16 v[146:147], v56 offset:37376
    ds_read_b128 v[148:151], v50 offset:32768
    s_waitcnt lgkmcnt(12)
    v_mfma_f32_32x32x16_bf16 v[32:47], v[176:179], v[180:183], v[32:47]
    ds_read_b64_tr_b16 v[152:153], v56 offset:38912
    ds_read_b64_tr_b16 v[154:155], v56 offset:39424
    ds_read_b128 v[156:159], v51 offset:32768
    s_waitcnt lgkmcnt(12)
    v_mfma_f32_32x32x16_bf16 v[32:47], v[184:187], v[188:191], v[32:47]
    ds_read_b64_tr_b16 v[160:161], v56 offset:40960
    ds_read_b64_tr_b16 v[162:163], v56 offset:41472
    ds_read_b128 v[164:167], v52 offset:32768
    s_waitcnt lgkmcnt(12)
    v_mfma_f32_32x32x16_bf16 v[32:47], v[128:131], v[132:135], v[32:47]
    ds_read_b64_tr_b16 v[168:169], v56 offset:43008
    ds_read_b64_tr_b16 v[170:171], v56 offset:43520
    ds_read_b128 v[172:175], v53 offset:32768
    s_waitcnt lgkmcnt(12)
    v_mfma_f32_32x32x16_bf16 v[32:47], v[136:139], v[140:143], v[32:47]
    ds_read_b64_tr_b16 v[176:177], v56 offset:45056
    ds_read_b64_tr_b16 v[178:179], v56 offset:45568
    ds_read_b128 v[180:183], v54 offset:32768
    s_waitcnt lgkmcnt(12)
    v_mfma_f32_32x32x16_bf16 v[32:47], v[144:147], v[148:151], v[32:47]
    ds_read_b64_tr_b16 v[184:185], v56 offset:47104
    ds_read_b64_tr_b16 v[186:187], v56 offset:47616
    ds_read_b128 v[188:191], v55 offset:32768
    s_waitcnt lgkmcnt(12)
    v_mfma_f32_32x32x16_bf16 v[32:47], v[152:155], v[156:159], v[32:47]
    s_barrier
    ds_read_b64_tr_b16 v[128:129], v56 offset:49152
    ds_read_b64_tr_b16 v[130:131], v56 offset:49664
    ds_read_b128 v[132:135], v48 offset:49152
    s_waitcnt lgkmcnt(12)
    v_mfma_f32_32x32x16_bf16 v[32:47], v[160:163], v[164:167], v[32:47]
    ds_read_b64_tr_b16 v[136:137], v56 offset:51200
    ds_read_b64_tr_b16 v[138:139], v56 offset:51712
    ds_read_b128 v[140:143], v49 offset:49152
    s_waitcnt lgkmcnt(12)
    v_mfma_f32_32x32x16_bf16 v[32:47], v[168:171], v[172:175], v[32:47]
    ds_read_b64_tr_b16 v[144:145], v56 offset:53248
    ds_read_b64_tr_b16 v[146:147], v56 offset:53760
    ds_read_b128 v[148:151], v50 offset:49152
    s_waitcnt lgkmcnt(12)
    v_mfma_f32_32x32x16_bf16 v[32:47], v[176:179], v[180:183], v[32:47]
    ds_read_b64_tr_b16 v[152:153], v56 offset:55296
    ds_read_b64_tr_b16 v[154:155], v56 offset:55808
    ds_read_b128 v[156:159], v51 offset:49152
    s_waitcnt lgkmcnt(12)
    v_mfma_f32_32x32x16_bf16 v[32:47], v[184:187], v[188:191], v[32:47]
    ds_read_b64_tr_b16 v[160:161], v56 offset:57344
    ds_read_b64_tr_b16 v[162:163], v56 offset:57856
    ds_read_b128 v[164:167], v52 offset:49152
    s_waitcnt lgkmcnt(12)
    v_mfma_f32_32x32x16_bf16 v[32:47], v[128:131], v[132:135], v[32:47]
    ds_read_b64_tr_b16 v[168:169], v56 offset:59392
    ds_read_b64_tr_b16 v[170:171], v56 offset:59904
    ds_read_b128 v[172:175], v53 offset:49152
    s_waitcnt lgkmcnt(12)
    v_mfma_f32_32x32x16_bf16 v[32:47], v[136:139], v[140:143], v[32:47]
    ds_read_b64_tr_b16 v[176:177], v56 offset:61440
    ds_read_b64_tr_b16 v[178:179], v56 offset:61952
    ds_read_b128 v[180:183], v54 offset:49152
    s_waitcnt lgkmcnt(12)
    v_mfma_f32_32x32x16_bf16 v[32:47], v[144:147], v[148:151], v[32:47]
    ds_read_b64_tr_b16 v[184:185], v56 offset:63488
    ds_read_b64_tr_b16 v[186:187], v56 offset:64000
    ds_read_b128 v[188:191], v55 offset:49152
    s_waitcnt lgkmcnt(12)
    v_mfma_f32_32x32x16_bf16 v[32:47], v[152:155], v[156:159], v[32:47]
    s_waitcnt lgkmcnt(9)
    v_mfma_f32_32x32x16_bf16 v[32:47], v[160:163], v[164:167], v[32:47]
    s_waitcnt lgkmcnt(6)
    v_mfma_f32_32x32x16_bf16 v[32:47], v[168:171], v[172:175], v[32:47]
    s_waitcnt lgkmcnt(3)
    v_mfma_f32_32x32x16_bf16 v[32:47], v[176:179], v[180:183], v[32:47]
    s_waitcnt lgkmcnt(0)
    v_mfma_f32_32x32x16_bf16 v[32:47], v[184:187], v[188:191], v[32:47]
    s_lshl_b32 s9, s15, 9
    s_add_u32 s9, s9, 148480
    v_lshlrev_b32 v13, 3, v0
    v_add_u32 v13, s9, v13
    v_lshlrev_b32 v15, 3, v17
    v_add_u32 v15, 148480, v15
    v_lshlrev_b32 v1, 2, v17
    v_lshl_add_u32 v1, v18, 14, v1
    s_lshl_b32 s9, s8, 15
    s_lshl_b32 s10, s15, 13
    s_add_u32 s50, s9, s10
    s_add_u32 s51, s50, 4096
    s_and_b32 s9, s5, 3
    s_lshl2_add_u32 s10, s9, s15
    s_lshl_b32 s10, s10, 15
    s_lshl_b32 s11, s6, 7
    s_add_u32 s10, s10, s11
    v_lshlrev_b32 v18, 10, v17
    v_add_u32 v18, s10, v18
    s_lshl2_add_u32 s9, s6, s9
    s_lshl_b32 s9, s9, 14
    s_and_b32 s10, s15, 1
    s_lshl_b32 s10, s10, 13
    s_add_u32 s9, s9, s10
    v_lshlrev_b32 v17, 7, v0
    v_add_u32 v17, s9, v17
    s_cmp_lt_u32 s15, 2
    s_cselect_b32 s98, s36, s38
    s_cselect_b32 s99, s37, s39
    s_and_b32 s9, s15, 1
    s_mul_i32 s9, s9, 33280
    v_add_u32 v28, s9, v5
    v_pk_mul_f32 v[32:33], v[32:33], v[58:59]
    v_pk_mul_f32 v[34:35], v[34:35], v[58:59]
    v_pk_mul_f32 v[36:37], v[36:37], v[58:59]
    v_pk_mul_f32 v[38:39], v[38:39], v[58:59]
    v_pk_mul_f32 v[40:41], v[40:41], v[58:59]
    v_pk_mul_f32 v[42:43], v[42:43], v[58:59]
    v_pk_mul_f32 v[44:45], v[44:45], v[58:59]
    v_pk_mul_f32 v[46:47], v[46:47], v[58:59]
    v_cvt_pk_bf16_f32 v32, v32, v33
    v_cvt_pk_bf16_f32 v33, v34, v35
    v_cvt_pk_bf16_f32 v34, v36, v37
    v_cvt_pk_bf16_f32 v35, v38, v39
    v_cvt_pk_bf16_f32 v36, v40, v41
    v_cvt_pk_bf16_f32 v37, v42, v43
    v_cvt_pk_bf16_f32 v38, v44, v45
    v_cvt_pk_bf16_f32 v39, v46, v47
    ds_write_b128 v57, v[32:35]
    ds_write_b128 v57, v[36:39] offset:2048
    v_lshrrev_b32 v121, 4, v0
    v_and_b32 v122, 15, v0
    v_lshl_add_u32 v121, s15, 2, v121
    v_xor_b32 v123, v122, v121
    v_lshlrev_b32 v123, 4, v123
    v_lshl_add_u32 v120, v121, 10, v123
    s_lshr_b32 s9, s15, 1
    s_lshl_b32 s9, s9, 13
    s_sub_u32 s9, 73728, s9
    v_add_u32 v112, s9, v48
    v_add_u32 v113, s9, v49
    v_add_u32 v114, s9, v50
    v_add_u32 v115, s9, v51
    v_add_u32 v116, s9, v52
    v_add_u32 v117, s9, v53
    v_add_u32 v118, s9, v54
    v_add_u32 v119, s9, v55
    s_lshl_b32 s50, s8, 15
    s_lshl_b32 s51, s15, 10
    s_lshr_b32 s9, s2, 1
    s_add_u32 s10, s9, 0
    s_and_b32 s10, s10, 3
    s_lshl_b32 s10, s10, 8
    s_add_u32 s16, s12, s10
    s_add_u32 s20, s50, s10
    s_add_u32 s10, s9, 1
    s_and_b32 s10, s10, 3
    s_lshl_b32 s10, s10, 8
    s_add_u32 s17, s12, s10
    s_add_u32 s21, s50, s10
    s_add_u32 s10, s9, 2
    s_and_b32 s10, s10, 3
    s_lshl_b32 s10, s10, 8
    s_add_u32 s18, s12, s10
    s_add_u32 s22, s50, s10
    s_add_u32 s10, s9, 3
    s_and_b32 s10, s10, 3
    s_lshl_b32 s10, s10, 8
    s_add_u32 s19, s12, s10
    s_add_u32 s23, s50, s10
    s_waitcnt lgkmcnt(0)
    s_barrier
    s_branch L_h2
L_a2:
    s_mov_b32 s14, 400000
    s_branch L_a_kvq
L_a_kvp:
    buffer_load_dword v22, v23, s[52:55], s9 offen sc1
L_a_kvq:
    s_waitcnt vmcnt(0)
    v_xor_b32 v22, s4, v22
    v_cmp_lt_u32 vcc, 15, v22
    s_cbranch_vccz L_a_kvok
    s_sub_u32 s14, s14, 1
    s_cbranch_scc0 L_a_kvp
L_a_kvok:
    s_lshl_b32 s9, s15, 15
    s_add_u32 s9, s9, 262144
    s_mov_b32 s68, 0xffff
    s_mov_b32 s69, 0xffff
    buffer_load_dwordx4 v[64:67], v14, s[52:55], s9 offen offset:0 sc1
    buffer_load_dwordx4 v[76:79], v14, s[52:55], s9 offen offset:2048 sc1
    s_mov_b64 exec, s[68:69]
    buffer_load_dwordx4 v[68:71], v15, s[52:55], s9 offen offset:1024 sc1
    buffer_load_dwordx4 v[72:75], v15, s[52:55], s9 offen offset:1536 sc1
    buffer_load_dwordx4 v[80:83], v15, s[52:55], s9 offen offset:3072 sc1
    buffer_load_dwordx4 v[84:87], v15, s[52:55], s9 offen offset:3584 sc1
    s_mov_b64 exec, -1
    s_add_u32 s9, s9, 4096
    buffer_load_dwordx4 v[88:91], v14, s[52:55], s9 offen offset:0 sc1
    buffer_load_dwordx4 v[100:103], v14, s[52:55], s9 offen offset:2048 sc1
    s_mov_b64 exec, s[68:69]
    buffer_load_dwordx4 v[92:95], v15, s[52:55], s9 offen offset:1024 sc1
    buffer_load_dwordx4 v[96:99], v15, s[52:55], s9 offen offset:1536 sc1
    buffer_load_dwordx4 v[104:107], v15, s[52:55], s9 offen offset:3072 sc1
    buffer_load_dwordx4 v[108:111], v15, s[52:55], s9 offen offset:3584 sc1
    s_mov_b64 exec, -1
    s_add_u32 s9, s9, 4096
    buffer_load_dwordx4 v[112:115], v14, s[52:55], s9 offen offset:0 sc1
    buffer_load_dwordx4 v[124:127], v14, s[52:55], s9 offen offset:2048 sc1
    s_mov_b64 exec, s[68:69]
    buffer_load_dwordx4 v[116:119], v15, s[52:55], s9 offen offset:1024 sc1
    buffer_load_dwordx4 v[120:123], v15, s[52:55], s9 offen offset:1536 sc1
    buffer_load_dwordx4 v[128:131], v15, s[52:55], s9 offen offset:3072 sc1
    buffer_load_dwordx4 v[132:135], v15, s[52:55], s9 offen offset:3584 sc1
    s_mov_b64 exec, -1
    s_add_u32 s9, s9, 4096
    s_bfe_u32 s10, s2, 0x20001
    s_cmp_eq_u32 s10, s15
    s_cbranch_scc0 L_a_nomode
    s_getreg_b32 s10, hwreg(HW_REG_XCC_ID, 0, 4)
    v_cmp_ne_u32 vcc, s10, v22
    s_bitcmp1_b32 s2, 0
    s_cselect_b32 s10, vcc_hi, vcc_lo
    s_cmp_eq_u32 s10, 0
    s_cselect_b32 s10, 1, 2
    v_mov_b32 v21, s10
    ds_write_b32 v12, v21 offset:44
L_a_nomode:
    s_barrier
    s_setprio 1
    ds_read_b128 v[8:11], v6
    v_add_u32 v6, 1024, v6
    s_waitcnt vmcnt(16) lgkmcnt(0)
    v_mfma_f32_32x32x16_bf16 v[16:31], v[64:67], v[8:11], 0
    v_mfma_f32_32x32x8_bf16 v[48:63], v[2:3], v[2:3], 0
    s_mov_b32 s72, 7
    buffer_load_dwordx4 v[136:139], v14, s[52:55], s9 offen offset:0 sc1
    buffer_load_dwordx4 v[148:151], v14, s[52:55], s9 offen offset:2048 sc1
    s_mov_b64 exec, s[68:69]
    buffer_load_dwordx4 v[140:143], v15, s[52:55], s9 offen offset:1024 sc1
    buffer_load_dwordx4 v[144:147], v15, s[52:55], s9 offen offset:1536 sc1
    buffer_load_dwordx4 v[152:155], v15, s[52:55], s9 offen offset:3072 sc1
    buffer_load_dwordx4 v[156:159], v15, s[52:55], s9 offen offset:3584 sc1
    s_mov_b64 exec, -1
    s_add_u32 s9, s9, 4096
    v_exp_f32 v16, v16
    v_exp_f32 v17, v17
    v_exp_f32 v18, v18
    v_exp_f32 v19, v19
    v_mfma_f32_32x32x16_bf16 v[32:47], v[76:79], v[8:11], 0
    v_exp_f32 v20, v20
    v_exp_f32 v21, v21
    v_exp_f32 v22, v22
    v_exp_f32 v23, v23
    v_exp_f32 v24, v24
    v_exp_f32 v25, v25
    v_exp_f32 v26, v26
    v_exp_f32 v27, v27
    s_waitcnt vmcnt(18)
    v_smfmac_f32_32x32x32_bf16 v[48:63], v[68:71], v[16:23], v1
    v_exp_f32 v28, v28
    v_exp_f32 v29, v29
    v_exp_f32 v30, v30
    v_exp_f32 v31, v31
    v_exp_f32 v32, v32
    v_exp_f32 v33, v33
    v_smfmac_f32_32x32x32_bf16 v[48:63], v[72:75], v[24:31], v1
    v_exp_f32 v34, v34
    v_exp_f32 v35, v35
    v_exp_f32 v36, v36
    v_exp_f32 v37, v37
    v_exp_f32 v38, v38
    s_waitcnt vmcnt(12)
    v_mfma_f32_32x32x16_bf16 v[16:31], v[88:91], v[8:11], 0
    v_exp_f32 v39, v39
    v_exp_f32 v40, v40
    v_exp_f32 v41, v41
    v_exp_f32 v42, v42
    v_exp_f32 v43, v43
    v_smfmac_f32_32x32x32_bf16 v[48:63], v[80:83], v[32:39], v1
    v_exp_f32 v44, v44
    v_exp_f32 v45, v45
    v_exp_f32 v46, v46
    v_exp_f32 v47, v47
    v_exp_f32 v16, v16
    v_exp_f32 v17, v17
    v_smfmac_f32_32x32x32_bf16 v[48:63], v[84:87], v[40:47], v1
    v_exp_f32 v18, v18
    v_exp_f32 v19, v19
    v_exp_f32 v20, v20
    v_exp_f32 v21, v21
    v_exp_f32 v22, v22
    v_mfma_f32_32x32x16_bf16 v[32:47], v[100:103], v[8:11], 0
    v_exp_f32 v23, v23
    v_exp_f32 v24, v24
    v_exp_f32 v25, v25
    v_exp_f32 v26, v26
    v_exp_f32 v27, v27
    v_smfmac_f32_32x32x32_bf16 v[48:63], v[92:95], v[16:23], v1
    buffer_load_dwordx4 v[160:163], v14, s[52:55], s9 offen offset:0 sc1
    buffer_load_dwordx4 v[172:175], v14, s[52:55], s9 offen offset:2048 sc1
    s_mov_b64 exec, s[68:69]
    buffer_load_dwordx4 v[164:167], v15, s[52:55], s9 offen offset:1024 sc1
    buffer_load_dwordx4 v[168:171], v15, s[52:55], s9 offen offset:1536 sc1
    buffer_load_dwordx4 v[176:179], v15, s[52:55], s9 offen offset:3072 sc1
    buffer_load_dwordx4 v[180:183], v15, s[52:55], s9 offen offset:3584 sc1
    s_mov_b64 exec, -1
    s_add_u32 s9, s9, 4096
    v_exp_f32 v28, v28
    v_exp_f32 v29, v29
    v_exp_f32 v30, v30
    v_exp_f32 v31, v31
    v_exp_f32 v32, v32
    v_exp_f32 v33, v33
    v_smfmac_f32_32x32x32_bf16 v[48:63], v[96:99], v[24:31], v1
    v_exp_f32 v34, v34
    v_exp_f32 v35, v35
    v_exp_f32 v36, v36
    v_exp_f32 v37, v37
    v_exp_f32 v38, v38
    s_waitcnt vmcnt(12)
    v_mfma_f32_32x32x16_bf16 v[16:31], v[112:115], v[8:11], 0
    v_exp_f32 v39, v39
    v_exp_f32 v40, v40
    v_exp_f32 v41, v41
    v_exp_f32 v42, v42
    v_exp_f32 v43, v43
    v_smfmac_f32_32x32x32_bf16 v[48:63], v[104:107], v[32:39], v1
    v_exp_f32 v44, v44
    v_exp_f32 v45, v45
    v_exp_f32 v46, v46
    v_exp_f32 v47, v47
    v_exp_f32 v16, v16
    v_exp_f32 v17, v17
    v_smfmac_f32_32x32x32_bf16 v[48:63], v[108:111], v[40:47], v1
    v_exp_f32 v18, v18
    v_exp_f32 v19, v19
    v_exp_f32 v20, v20
    v_exp_f32 v21, v21
    v_exp_f32 v22, v22
    v_mfma_f32_32x32x16_bf16 v[32:47], v[124:127], v[8:11], 0
    v_exp_f32 v23, v23
    v_exp_f32 v24, v24
    v_exp_f32 v25, v25
    v_exp_f32 v26, v26
    v_exp_f32 v27, v27
    v_smfmac_f32_32x32x32_bf16 v[48:63], v[116:119], v[16:23], v1
    buffer_load_dwordx4 v[184:187], v14, s[52:55], s9 offen offset:0 sc1
    buffer_load_dwordx4 v[196:199], v14, s[52:55], s9 offen offset:2048 sc1
    s_mov_b64 exec, s[68:69]
    buffer_load_dwordx4 v[188:191], v15, s[52:55], s9 offen offset:1024 sc1
    buffer_load_dwordx4 v[192:195], v15, s[52:55], s9 offen offset:1536 sc1
    buffer_load_dwordx4 v[200:203], v15, s[52:55], s9 offen offset:3072 sc1
    buffer_load_dwordx4 v[204:207], v15, s[52:55], s9 offen offset:3584 sc1
    s_mov_b64 exec, -1
    s_add_u32 s9, s9, 4096
    v_exp_f32 v28, v28
    v_exp_f32 v29, v29
    v_exp_f32 v30, v30
    v_exp_f32 v31, v31
    v_exp_f32 v32, v32
    v_exp_f32 v33, v33
    v_smfmac_f32_32x32x32_bf16 v[48:63], v[120:123], v[24:31], v1
    v_exp_f32 v34, v34
    v_exp_f32 v35, v35
    v_exp_f32 v36, v36
    v_exp_f32 v37, v37
    v_exp_f32 v38, v38
    s_waitcnt vmcnt(12)
    v_mfma_f32_32x32x16_bf16 v[16:31], v[136:139], v[8:11], 0
    v_exp_f32 v39, v39
    v_exp_f32 v40, v40
    v_exp_f32 v41, v41
    v_exp_f32 v42, v42
    v_exp_f32 v43, v43
    v_smfmac_f32_32x32x32_bf16 v[48:63], v[128:131], v[32:39], v1
    v_exp_f32 v44, v44
    v_exp_f32 v45, v45
    v_exp_f32 v46, v46
    v_exp_f32 v47, v47
    v_exp_f32 v16, v16
    v_exp_f32 v17, v17
    v_smfmac_f32_32x32x32_bf16 v[48:63], v[132:135], v[40:47], v1
    v_exp_f32 v18, v18
    v_exp_f32 v19, v19
    v_exp_f32 v20, v20
    v_exp_f32 v21, v21
    v_exp_f32 v22, v22
    v_mfma_f32_32x32x16_bf16 v[32:47], v[148:151], v[8:11], 0
    v_exp_f32 v23, v23
    v_exp_f32 v24, v24
    v_exp_f32 v25, v25
    v_exp_f32 v26, v26
    v_exp_f32 v27, v27
    v_smfmac_f32_32x32x32_bf16 v[48:63], v[140:143], v[16:23], v1
    buffer_load_dwordx4 v[208:211], v14, s[52:55], s9 offen offset:0 sc1
    buffer_load_dwordx4 v[220:223], v14, s[52:55], s9 offen offset:2048 sc1
    s_mov_b64 exec, s[68:69]
    buffer_load_dwordx4 v[212:215], v15, s[52:55], s9 offen offset:1024 sc1
    buffer_load_dwordx4 v[216:219], v15, s[52:55], s9 offen offset:1536 sc1
    buffer_load_dwordx4 v[224:227], v15, s[52:55], s9 offen offset:3072 sc1
    buffer_load_dwordx4 v[228:231], v15, s[52:55], s9 offen offset:3584 sc1
    s_mov_b64 exec, -1
    s_add_u32 s9, s9, 4096
    v_exp_f32 v28, v28
    v_exp_f32 v29, v29
    v_exp_f32 v30, v30
    v_exp_f32 v31, v31
    v_exp_f32 v32, v32
    v_exp_f32 v33, v33
    v_smfmac_f32_32x32x32_bf16 v[48:63], v[144:147], v[24:31], v1
    v_exp_f32 v34, v34
    v_exp_f32 v35, v35
    v_exp_f32 v36, v36
    v_exp_f32 v37, v37
    v_exp_f32 v38, v38
    s_waitcnt vmcnt(12)
    v_mfma_f32_32x32x16_bf16 v[16:31], v[160:163], v[8:11], 0
    v_exp_f32 v39, v39
    v_exp_f32 v40, v40
    v_exp_f32 v41, v41
    v_exp_f32 v42, v42
    v_exp_f32 v43, v43
    v_smfmac_f32_32x32x32_bf16 v[48:63], v[152:155], v[32:39], v1
    v_exp_f32 v44, v44
    v_exp_f32 v45, v45
    v_exp_f32 v46, v46
    v_exp_f32 v47, v47
    v_exp_f32 v16, v16
    v_exp_f32 v17, v17
    v_smfmac_f32_32x32x32_bf16 v[48:63], v[156:159], v[40:47], v1
    v_exp_f32 v18, v18
    v_exp_f32 v19, v19
    v_exp_f32 v20, v20
    v_exp_f32 v21, v21
    v_exp_f32 v22, v22
    v_mfma_f32_32x32x16_bf16 v[32:47], v[172:175], v[8:11], 0
    v_exp_f32 v23, v23
    v_exp_f32 v24, v24
    v_exp_f32 v25, v25
    v_exp_f32 v26, v26
    v_exp_f32 v27, v27
    v_smfmac_f32_32x32x32_bf16 v[48:63], v[164:167], v[16:23], v1
    buffer_load_dwordx4 v[232:235], v14, s[52:55], s9 offen offset:0 sc1
    buffer_load_dwordx4 v[244:247], v14, s[52:55], s9 offen offset:2048 sc1
    s_mov_b64 exec, s[68:69]
    buffer_load_dwordx4 v[236:239], v15, s[52:55], s9 offen offset:1024 sc1
    buffer_load_dwordx4 v[240:243], v15, s[52:55], s9 offen offset:1536 sc1
    buffer_load_dwordx4 v[248:251], v15, s[52:55], s9 offen offset:3072 sc1
    buffer_load_dwordx4 v[252:255], v15, s[52:55], s9 offen offset:3584 sc1
    s_mov_b64 exec, -1
    s_mov_b64 exec, 1
    ds_add_u32 v12, v13 offset:16
    s_mov_b64 exec, -1
    v_exp_f32 v28, v28
    v_exp_f32 v29, v29
    v_exp_f32 v30, v30
    v_exp_f32 v31, v31
    v_exp_f32 v32, v32
    v_exp_f32 v33, v33
    v_smfmac_f32_32x32x32_bf16 v[48:63], v[168:171], v[24:31], v1
    v_exp_f32 v34, v34
    v_exp_f32 v35, v35
    v_exp_f32 v36, v36
    v_exp_f32 v37, v37
    v_exp_f32 v38, v38
    s_waitcnt vmcnt(12)
    v_mfma_f32_32x32x16_bf16 v[16:31], v[184:187], v[8:11], 0
    v_exp_f32 v39, v39
    v_exp_f32 v40, v40
    v_exp_f32 v41, v41
    v_exp_f32 v42, v42
    v_exp_f32 v43, v43
    v_smfmac_f32_32x32x32_bf16 v[48:63], v[176:179], v[32:39], v1
    v_exp_f32 v44, v44
    v_exp_f32 v45, v45
    v_exp_f32 v46, v46
    v_exp_f32 v47, v47
    v_exp_f32 v16, v16
    v_exp_f32 v17, v17
    v_smfmac_f32_32x32x32_bf16 v[48:63], v[180:183], v[40:47], v1
    v_exp_f32 v18, v18
    v_exp_f32 v19, v19
    v_exp_f32 v20, v20
    v_exp_f32 v21, v21
    v_exp_f32 v22, v22
    v_mfma_f32_32x32x16_bf16 v[32:47], v[196:199], v[8:11], 0
    v_exp_f32 v23, v23
    v_exp_f32 v24, v24
    v_exp_f32 v25, v25
    v_exp_f32 v26, v26
    v_exp_f32 v27, v27
    v_smfmac_f32_32x32x32_bf16 v[48:63], v[188:191], v[16:23], v1
    v_exp_f32 v28, v28
    v_exp_f32 v29, v29
    v_exp_f32 v30, v30
    v_exp_f32 v31, v31
    v_exp_f32 v32, v32
    v_exp_f32 v33, v33
    v_smfmac_f32_32x32x32_bf16 v[48:63], v[192:195], v[24:31], v1
    v_exp_f32 v34, v34
    v_exp_f32 v35, v35
    v_exp_f32 v36, v36
    v_exp_f32 v37, v37
    v_exp_f32 v38, v38
    s_waitcnt vmcnt(6)
    v_mfma_f32_32x32x16_bf16 v[16:31], v[208:211], v[8:11], 0
    v_exp_f32 v39, v39
    v_exp_f32 v40, v40
    v_exp_f32 v41, v41
    v_exp_f32 v42, v42
    v_exp_f32 v43, v43
    v_smfmac_f32_32x32x32_bf16 v[48:63], v[200:203], v[32:39], v1
    v_exp_f32 v44, v44
    v_exp_f32 v45, v45
    v_exp_f32 v46, v46
    v_exp_f32 v47, v47
    v_exp_f32 v16, v16
    v_exp_f32 v17, v17
    v_smfmac_f32_32x32x32_bf16 v[48:63], v[204:207], v[40:47], v1
    v_exp_f32 v18, v18
    v_exp_f32 v19, v19
    v_exp_f32 v20, v20
    v_exp_f32 v21, v21
    v_exp_f32 v22, v22
    v_mfma_f32_32x32x16_bf16 v[32:47], v[220:223], v[8:11], 0
    v_exp_f32 v23, v23
    v_exp_f32 v24, v24
    v_exp_f32 v25, v25
    v_exp_f32 v26, v26
    v_exp_f32 v27, v27
    v_smfmac_f32_32x32x32_bf16 v[48:63], v[212:215], v[16:23], v1
    v_exp_f32 v28, v28
    v_exp_f32 v29, v29
    v_exp_f32 v30, v30
    v_exp_f32 v31, v31
    v_exp_f32 v32, v32
    v_exp_f32 v33, v33
    v_smfmac_f32_32x32x32_bf16 v[48:63], v[216:219], v[24:31], v1
    v_exp_f32 v34, v34
    v_exp_f32 v35, v35
    v_exp_f32 v36, v36
    v_exp_f32 v37, v37
    v_exp_f32 v38, v38
    s_waitcnt vmcnt(0)
    v_mfma_f32_32x32x16_bf16 v[16:31], v[232:235], v[8:11], 0
    v_exp_f32 v39, v39
    v_exp_f32 v40, v40
    v_exp_f32 v41, v41
    v_exp_f32 v42, v42
    v_exp_f32 v43, v43
    v_smfmac_f32_32x32x32_bf16 v[48:63], v[224:227], v[32:39], v1
    v_exp_f32 v44, v44
    v_exp_f32 v45, v45
    v_exp_f32 v46, v46
    v_exp_f32 v47, v47
    v_exp_f32 v16, v16
    v_exp_f32 v17, v17
    v_smfmac_f32_32x32x32_bf16 v[48:63], v[228:231], v[40:47], v1
    v_exp_f32 v18, v18
    v_exp_f32 v19, v19
    v_exp_f32 v20, v20
    v_exp_f32 v21, v21
    v_exp_f32 v22, v22
    v_mfma_f32_32x32x16_bf16 v[32:47], v[244:247], v[8:11], 0
    ds_read_b128 v[8:11], v6
    v_add_u32 v6, 1024, v6
    v_exp_f32 v23, v23
    v_exp_f32 v24, v24
    v_exp_f32 v25, v25
    v_exp_f32 v26, v26
    v_exp_f32 v27, v27
    v_smfmac_f32_32x32x32_bf16 v[48:63], v[236:239], v[16:23], v1
    v_exp_f32 v28, v28
    v_exp_f32 v29, v29
    v_exp_f32 v30, v30
    v_exp_f32 v31, v31
    v_exp_f32 v32, v32
    v_exp_f32 v33, v33
    v_smfmac_f32_32x32x32_bf16 v[48:63], v[240:243], v[24:31], v1
    v_exp_f32 v34, v34
    v_exp_f32 v35, v35
    v_exp_f32 v36, v36
    v_exp_f32 v37, v37
    v_exp_f32 v38, v38
    s_waitcnt lgkmcnt(0)
    v_mfma_f32_32x32x16_bf16 v[16:31], v[64:67], v[8:11], 0
    v_exp_f32 v39, v39
    v_exp_f32 v40, v40
    v_exp_f32 v41, v41
    v_exp_f32 v42, v42
    v_exp_f32 v43, v43
    v_smfmac_f32_32x32x32_bf16 v[48:63], v[248:251], v[32:39], v1
    v_exp_f32 v44, v44
    v_exp_f32 v45, v45
    v_exp_f32 v46, v46
    v_exp_f32 v47, v47
    s_mov_b32 s72, 6
    s_nop 0
.p2align 6
L_a_loop:
    v_smfmac_f32_32x32x32_bf16 v[48:63], v[252:255], v[40:47], v1
    v_exp_f32 v16, v16
    v_exp_f32 v17, v17
    v_exp_f32 v18, v18
    v_mfma_f32_32x32x16_bf16 v[32:47], v[76:79], v[8:11], 0
    v_exp_f32 v19, v19
    v_exp_f32 v20, v20
    v_exp_f32 v21, v21
    ds_write_b128 v4, v[48:51]
    ds_write_b128 v4, v[52:55] offset:1024
    ds_write_b32 v5, v56
    ds_write_b32 v7, v5
    v_exp_f32 v22, v22
    v_mfma_f32_32x32x8_bf16 v[48:63], v[2:3], v[2:3], 0
    v_exp_f32 v23, v23
    v_exp_f32 v24, v24
    v_exp_f32 v25, v25
    v_exp_f32 v26, v26
    v_exp_f32 v27, v27
    v_add_u32 v4, 9216, v4
    v_add_u32 v5, 9216, v5
    v_smfmac_f32_32x32x32_bf16 v[48:63], v[68:71], v[16:23], v1
    v_exp_f32 v28, v28
    v_exp_f32 v29, v29
    v_exp_f32 v30, v30
    v_exp_f32 v31, v31
    v_exp_f32 v32, v32
    v_exp_f32 v33, v33
    v_smfmac_f32_32x32x32_bf16 v[48:63], v[72:75], v[24:31], v1
    v_exp_f32 v34, v34
    v_exp_f32 v35, v35
    v_exp_f32 v36, v36
    v_exp_f32 v37, v37
    v_exp_f32 v38, v38
    v_mfma_f32_32x32x16_bf16 v[16:31], v[88:91], v[8:11], 0
    v_exp_f32 v39, v39
    v_exp_f32 v40, v40
    v_exp_f32 v41, v41
    v_exp_f32 v42, v42
    v_exp_f32 v43, v43
    v_smfmac_f32_32x32x32_bf16 v[48:63], v[80:83], v[32:39], v1
    v_exp_f32 v44, v44
    v_exp_f32 v45, v45
    v_exp_f32 v46, v46
    v_exp_f32 v47, v47
    v_exp_f32 v16, v16
    v_exp_f32 v17, v17
    v_smfmac_f32_32x32x32_bf16 v[48:63], v[84:87], v[40:47], v1
    v_exp_f32 v18, v18
    v_exp_f32 v19, v19
    v_exp_f32 v20, v20
    v_exp_f32 v21, v21
    v_exp_f32 v22, v22
    v_mfma_f32_32x32x16_bf16 v[32:47], v[100:103], v[8:11], 0
    v_exp_f32 v23, v23
    v_exp_f32 v24, v24
    v_exp_f32 v25, v25
    v_exp_f32 v26, v26
    v_exp_f32 v27, v27
    v_smfmac_f32_32x32x32_bf16 v[48:63], v[92:95], v[16:23], v1
    v_exp_f32 v28, v28
    v_exp_f32 v29, v29
    v_exp_f32 v30, v30
    v_exp_f32 v31, v31
    v_exp_f32 v32, v32
    v_exp_f32 v33, v33
    v_smfmac_f32_32x32x32_bf16 v[48:63], v[96:99], v[24:31], v1
    v_exp_f32 v34, v34
    v_exp_f32 v35, v35
    v_exp_f32 v36, v36
    v_exp_f32 v37, v37
    v_exp_f32 v38, v38
    v_mfma_f32_32x32x16_bf16 v[16:31], v[112:115], v[8:11], 0
    v_exp_f32 v39, v39
    v_exp_f32 v40, v40
    v_exp_f32 v41, v41
    v_exp_f32 v42, v42
    v_exp_f32 v43, v43
    v_smfmac_f32_32x32x32_bf16 v[48:63], v[104:107], v[32:39], v1
    v_exp_f32 v44, v44
    v_exp_f32 v45, v45
    v_exp_f32 v46, v46
    v_exp_f32 v47, v47
    v_exp_f32 v16, v16
    v_exp_f32 v17, v17
    v_smfmac_f32_32x32x32_bf16 v[48:63], v[108:111], v[40:47], v1
    v_exp_f32 v18, v18
    v_exp_f32 v19, v19
    v_exp_f32 v20, v20
    v_exp_f32 v21, v21
    v_exp_f32 v22, v22
    v_mfma_f32_32x32x16_bf16 v[32:47], v[124:127], v[8:11], 0
    v_exp_f32 v23, v23
    v_exp_f32 v24, v24
    v_exp_f32 v25, v25
    v_exp_f32 v26, v26
    v_exp_f32 v27, v27
    v_smfmac_f32_32x32x32_bf16 v[48:63], v[116:119], v[16:23], v1
    v_exp_f32 v28, v28
    v_exp_f32 v29, v29
    v_exp_f32 v30, v30
    v_exp_f32 v31, v31
    v_exp_f32 v32, v32
    v_exp_f32 v33, v33
    v_smfmac_f32_32x32x32_bf16 v[48:63], v[120:123], v[24:31], v1
    v_exp_f32 v34, v34
    v_exp_f32 v35, v35
    v_exp_f32 v36, v36
    v_exp_f32 v37, v37
    v_exp_f32 v38, v38
    v_mfma_f32_32x32x16_bf16 v[16:31], v[136:139], v[8:11], 0
    v_exp_f32 v39, v39
    v_exp_f32 v40, v40
    v_exp_f32 v41, v41
    v_exp_f32 v42, v42
    v_exp_f32 v43, v43
    v_smfmac_f32_32x32x32_bf16 v[48:63], v[128:131], v[32:39], v1
    v_exp_f32 v44, v44
    v_exp_f32 v45, v45
    v_exp_f32 v46, v46
    v_exp_f32 v47, v47
    v_exp_f32 v16, v16
    v_exp_f32 v17, v17
    v_smfmac_f32_32x32x32_bf16 v[48:63], v[132:135], v[40:47], v1
    v_exp_f32 v18, v18
    v_exp_f32 v19, v19
    v_exp_f32 v20, v20
    v_exp_f32 v21, v21
    v_exp_f32 v22, v22
    v_mfma_f32_32x32x16_bf16 v[32:47], v[148:151], v[8:11], 0
    v_exp_f32 v23, v23
    v_exp_f32 v24, v24
    v_exp_f32 v25, v25
    v_exp_f32 v26, v26
    v_exp_f32 v27, v27
    v_smfmac_f32_32x32x32_bf16 v[48:63], v[140:143], v[16:23], v1
    v_exp_f32 v28, v28
    v_exp_f32 v29, v29
    v_exp_f32 v30, v30
    v_exp_f32 v31, v31
    v_exp_f32 v32, v32
    v_exp_f32 v33, v33
    v_smfmac_f32_32x32x32_bf16 v[48:63], v[144:147], v[24:31], v1
    v_exp_f32 v34, v34
    v_exp_f32 v35, v35
    v_exp_f32 v36, v36
    v_exp_f32 v37, v37
    v_exp_f32 v38, v38
    v_mfma_f32_32x32x16_bf16 v[16:31], v[160:163], v[8:11], 0
    v_exp_f32 v39, v39
    v_exp_f32 v40, v40
    v_exp_f32 v41, v41
    v_exp_f32 v42, v42
    v_exp_f32 v43, v43
    v_smfmac_f32_32x32x32_bf16 v[48:63], v[152:155], v[32:39], v1
    v_exp_f32 v44, v44
    v_exp_f32 v45, v45
    v_exp_f32 v46, v46
    v_exp_f32 v47, v47
    v_exp_f32 v16, v16
    v_exp_f32 v17, v17
    v_smfmac_f32_32x32x32_bf16 v[48:63], v[156:159], v[40:47], v1
    v_exp_f32 v18, v18
    v_exp_f32 v19, v19
    v_exp_f32 v20, v20
    v_exp_f32 v21, v21
    v_exp_f32 v22, v22
    v_mfma_f32_32x32x16_bf16 v[32:47], v[172:175], v[8:11], 0
    v_exp_f32 v23, v23
    v_exp_f32 v24, v24
    v_exp_f32 v25, v25
    v_exp_f32 v26, v26
    v_exp_f32 v27, v27
    v_smfmac_f32_32x32x32_bf16 v[48:63], v[164:167], v[16:23], v1
    v_exp_f32 v28, v28
    v_exp_f32 v29, v29
    v_exp_f32 v30, v30
    v_exp_f32 v31, v31
    v_exp_f32 v32, v32
    v_exp_f32 v33, v33
    v_smfmac_f32_32x32x32_bf16 v[48:63], v[168:171], v[24:31], v1
    v_exp_f32 v34, v34
    v_exp_f32 v35, v35
    v_exp_f32 v36, v36
    v_exp_f32 v37, v37
    v_exp_f32 v38, v38
    v_mfma_f32_32x32x16_bf16 v[16:31], v[184:187], v[8:11], 0
    v_exp_f32 v39, v39
    v_exp_f32 v40, v40
    v_exp_f32 v41, v41
    v_exp_f32 v42, v42
    v_exp_f32 v43, v43
    v_smfmac_f32_32x32x32_bf16 v[48:63], v[176:179], v[32:39], v1
    v_exp_f32 v44, v44
    v_exp_f32 v45, v45
    v_exp_f32 v46, v46
    v_exp_f32 v47, v47
    v_exp_f32 v16, v16
    v_exp_f32 v17, v17
    v_smfmac_f32_32x32x32_bf16 v[48:63], v[180:183], v[40:47], v1
    v_exp_f32 v18, v18
    v_exp_f32 v19, v19
    v_exp_f32 v20, v20
    v_exp_f32 v21, v21
    v_exp_f32 v22, v22
    v_mfma_f32_32x32x16_bf16 v[32:47], v[196:199], v[8:11], 0
    v_exp_f32 v23, v23
    v_exp_f32 v24, v24
    v_exp_f32 v25, v25
    v_exp_f32 v26, v26
    v_exp_f32 v27, v27
    v_smfmac_f32_32x32x32_bf16 v[48:63], v[188:191], v[16:23], v1
    v_exp_f32 v28, v28
    v_exp_f32 v29, v29
    v_exp_f32 v30, v30
    v_exp_f32 v31, v31
    v_exp_f32 v32, v32
    v_exp_f32 v33, v33
    v_smfmac_f32_32x32x32_bf16 v[48:63], v[192:195], v[24:31], v1
    v_exp_f32 v34, v34
    v_exp_f32 v35, v35
    v_exp_f32 v36, v36
    v_exp_f32 v37, v37
    v_exp_f32 v38, v38
    v_mfma_f32_32x32x16_bf16 v[16:31], v[208:211], v[8:11], 0
    v_exp_f32 v39, v39
    v_exp_f32 v40, v40
    v_exp_f32 v41, v41
    v_exp_f32 v42, v42
    v_exp_f32 v43, v43
    v_smfmac_f32_32x32x32_bf16 v[48:63], v[200:203], v[32:39], v1
    v_exp_f32 v44, v44
    v_exp_f32 v45, v45
    v_exp_f32 v46, v46
    v_exp_f32 v47, v47
    v_exp_f32 v16, v16
    v_exp_f32 v17, v17
    v_smfmac_f32_32x32x32_bf16 v[48:63], v[204:207], v[40:47], v1
    v_exp_f32 v18, v18
    v_exp_f32 v19, v19
    v_exp_f32 v20, v20
    v_exp_f32 v21, v21
    v_exp_f32 v22, v22
    v_mfma_f32_32x32x16_bf16 v[32:47], v[220:223], v[8:11], 0
    v_exp_f32 v23, v23
    v_exp_f32 v24, v24
    v_exp_f32 v25, v25
    v_exp_f32 v26, v26
    v_exp_f32 v27, v27
    v_smfmac_f32_32x32x32_bf16 v[48:63], v[212:215], v[16:23], v1
    v_exp_f32 v28, v28
    v_exp_f32 v29, v29
    v_exp_f32 v30, v30
    v_exp_f32 v31, v31
    v_exp_f32 v32, v32
    v_exp_f32 v33, v33
    v_smfmac_f32_32x32x32_bf16 v[48:63], v[216:219], v[24:31], v1
    v_exp_f32 v34, v34
    v_exp_f32 v35, v35
    v_exp_f32 v36, v36
    v_exp_f32 v37, v37
    v_exp_f32 v38, v38
    v_mfma_f32_32x32x16_bf16 v[16:31], v[232:235], v[8:11], 0
    v_exp_f32 v39, v39
    v_exp_f32 v40, v40
    v_exp_f32 v41, v41
    v_exp_f32 v42, v42
    v_exp_f32 v43, v43
    v_smfmac_f32_32x32x32_bf16 v[48:63], v[224:227], v[32:39], v1
    v_exp_f32 v44, v44
    v_exp_f32 v45, v45
    v_exp_f32 v46, v46
    v_exp_f32 v47, v47
    v_exp_f32 v16, v16
    v_exp_f32 v17, v17
    v_smfmac_f32_32x32x32_bf16 v[48:63], v[228:231], v[40:47], v1
    v_exp_f32 v18, v18
    v_exp_f32 v19, v19
    v_exp_f32 v20, v20
    v_exp_f32 v21, v21
    v_exp_f32 v22, v22
    v_mfma_f32_32x32x16_bf16 v[32:47], v[244:247], v[8:11], 0
    ds_read_b128 v[8:11], v6
    v_add_u32 v6, 1024, v6
    v_exp_f32 v23, v23
    v_exp_f32 v24, v24
    v_exp_f32 v25, v25
    v_exp_f32 v26, v26
    v_exp_f32 v27, v27
    v_smfmac_f32_32x32x32_bf16 v[48:63], v[236:239], v[16:23], v1
    v_exp_f32 v28, v28
    v_exp_f32 v29, v29
    v_exp_f32 v30, v30
    v_exp_f32 v31, v31
    v_exp_f32 v32, v32
    v_exp_f32 v33, v33
    v_smfmac_f32_32x32x32_bf16 v[48:63], v[240:243], v[24:31], v1
    v_exp_f32 v34, v34
    v_exp_f32 v35, v35
    v_exp_f32 v36, v36
    v_exp_f32 v37, v37
    v_exp_f32 v38, v38
    s_waitcnt lgkmcnt(0)
    v_mfma_f32_32x32x16_bf16 v[16:31], v[64:67], v[8:11], 0
    v_exp_f32 v39, v39
    v_exp_f32 v40, v40
    v_exp_f32 v41, v41
    v_exp_f32 v42, v42
    v_exp_f32 v43, v43
    v_smfmac_f32_32x32x32_bf16 v[48:63], v[248:251], v[32:39], v1
    v_exp_f32 v44, v44
    v_exp_f32 v45, v45
    v_exp_f32 v46, v46
    v_exp_f32 v47, v47
    s_sub_u32 s72, s72, 1
    s_cbranch_scc0 L_a_loop
L_a_fin:
    v_smfmac_f32_32x32x32_bf16 v[48:63], v[252:255], v[40:47], v1
    v_lshlrev_b32 v14, 4, v0
    v_mov_b32 v12, 159744
    v_add_u32 v9, s11, v14
    v_and_b32 v10, 3, v0
    v_lshlrev_b32 v10, 2, v10
    v_add_u32 v10, 158720, v10
    s_add_u32 s11, s11, 8192
    v_add_u32 v6, s13, v14
    v_lshlrev_b32 v16, 2, v0
    v_mov_b32 v17, s4
    s_setprio 3
    ds_write_b128 v4, v[48:51]
    ds_write_b128 v4, v[52:55] offset:1024
    ds_write_b32 v5, v56
    ds_write_b32 v7, v5
    v_lshlrev_b32 v7, 3, v0
    v_add_u32 v7, s50, v7
    s_mov_b32 s71, 0
L_a_rw:
    ds_read_b32 v11, v10
    ds_read_b32 v8, v12 offset:44
    ds_read_b128 v[52:55], v9 offset:8192
    ds_read_b128 v[20:23], v9 offset:0
    ds_read_b128 v[24:27], v9 offset:1024
    ds_read_b128 v[28:31], v9 offset:2048
    ds_read_b128 v[32:35], v9 offset:3072
    ds_read_b128 v[36:39], v9 offset:4096
    ds_read_b128 v[40:43], v9 offset:5120
    ds_read_b128 v[44:47], v9 offset:6144
    ds_read_b128 v[48:51], v9 offset:7168
    ds_read_b128 v[56:59], v6 offset:8192
    ds_read_b32 v60, v12 offset:24
    ds_read_b64 v[4:5], v7
    s_waitcnt lgkmcnt(11)
    v_cmp_gt_u32 vcc, s11, v11
    s_cbranch_vccnz L_a_rw
    v_readfirstlane_b32 s70, v8
    s_mov_b32 s10, s1
    v_pk_add_f32 v[52:53], v[52:53], v[54:55]
    v_add_f32 v52, v52, v53
    v_cmp_nle_f32 vcc, s78, v52
    v_cmp_nge_f32 s[68:69], s79, v52
    s_or_b64 vcc, vcc, s[68:69]
    s_waitcnt lgkmcnt(3)
    s_cbranch_scc1 L_a_bad1
    v_rcp_f32 v54, v52
    v_pk_add_f32 v[20:21], v[20:21], v[28:29]
    v_pk_add_f32 v[22:23], v[22:23], v[30:31]
    v_pk_add_f32 v[24:25], v[24:25], v[32:33]
    v_pk_add_f32 v[26:27], v[26:27], v[34:35]
    v_pk_add_f32 v[36:37], v[36:37], v[44:45]
    v_pk_add_f32 v[38:39], v[38:39], v[46:47]
    v_pk_add_f32 v[40:41], v[40:41], v[48:49]
    v_pk_add_f32 v[42:43], v[42:43], v[50:51]
    v_pk_add_f32 v[20:21], v[20:21], v[36:37]
    v_pk_add_f32 v[22:23], v[22:23], v[38:39]
    v_pk_add_f32 v[24:25], v[24:25], v[40:41]
    v_pk_add_f32 v[26:27], v[26:27], v[42:43]
    v_pk_mul_f32 v[20:21], v[20:21], v[54:55] op_sel_hi:[1,0]
    v_pk_mul_f32 v[22:23], v[22:23], v[54:55] op_sel_hi:[1,0]
    v_pk_mul_f32 v[24:25], v[24:25], v[54:55] op_sel_hi:[1,0]
    v_pk_mul_f32 v[26:27], v[26:27], v[54:55] op_sel_hi:[1,0]
    v_cvt_pk_bf16_f32 v28, v20, v21
    v_cvt_pk_bf16_f32 v29, v22, v23
    v_cvt_pk_bf16_f32 v30, v24, v25
    v_cvt_pk_bf16_f32 v31, v26, v27
    s_cmp_eq_u32 s70, 1
    s_cbranch_scc1 L_sl1
    buffer_store_dwordx4 v[28:31], v14, s[52:55], s10 offen sc1
    s_branch L_se2
L_sl1:
    buffer_store_dwordx4 v[28:31], v14, s[52:55], s10 offen
L_se2:
    v_and_b32 v15, 15, v0
    v_lshlrev_b32 v15, 7, v15
    s_lshl_b32 s9, s15, 2
    v_add_u32 v10, s9, v12
    s_waitcnt lgkmcnt(0)
    v_cmp_gt_u32 vcc, NSYNC_B2, v60
    s_cbranch_vccnz L_a_nosh
    s_mov_b32 s71, 1
    ds_read_b64_tr_b16 v[152:153], v4 offset:0
    ds_read_b64_tr_b16 v[154:155], v4 offset:1024
    ds_read_b64_tr_b16 v[156:157], v4 offset:2048
    ds_read_b64_tr_b16 v[158:159], v4 offset:3072
    ds_read_b64_tr_b16 v[160:161], v4 offset:4096
    ds_read_b64_tr_b16 v[162:163], v4 offset:5120
    ds_read_b64_tr_b16 v[164:165], v4 offset:6144
    ds_read_b64_tr_b16 v[166:167], v4 offset:7168
    ds_read_b64_tr_b16 v[168:169], v4 offset:9216
    ds_read_b64_tr_b16 v[170:171], v4 offset:10240
    ds_read_b64_tr_b16 v[172:173], v4 offset:11264
    ds_read_b64_tr_b16 v[174:175], v4 offset:12288
    ds_read_b64_tr_b16 v[176:177], v4 offset:13312
    ds_read_b64_tr_b16 v[178:179], v4 offset:14336
    ds_read_b64_tr_b16 v[180:181], v4 offset:15360
    ds_read_b64_tr_b16 v[182:183], v4 offset:16384
    ds_read_b64_tr_b16 v[184:185], v4 offset:18432
    ds_read_b64_tr_b16 v[186:187], v4 offset:19456
    ds_read_b64_tr_b16 v[188:189], v4 offset:20480
    ds_read_b64_tr_b16 v[190:191], v4 offset:21504
    ds_read_b64_tr_b16 v[192:193], v4 offset:22528
    ds_read_b64_tr_b16 v[194:195], v4 offset:23552
    ds_read_b64_tr_b16 v[196:197], v4 offset:24576
    ds_read_b64_tr_b16 v[198:199], v4 offset:25600
L_a_nosh:
    s_waitcnt vmcnt(0)
    s_mov_b32 exec_hi, 0
    s_cmp_eq_u32 s70, 1
    s_cbranch_scc1 L_sl3
    buffer_store_dword v17, v16, s[52:55], s0 offen sc1
    s_branch L_se4
L_sl3:
    buffer_store_dword v17, v16, s[52:55], s0 offen
L_se4:
    s_mov_b64 exec, -1
L_a_ok1:
    v_pk_add_f32 v[56:57], v[56:57], v[58:59]
    v_add_f32 v56, v56, v57
    v_cmp_nle_f32 vcc, s78, v56
    v_cmp_nge_f32 s[68:69], s79, v56
    s_or_b64 vcc, vcc, s[68:69]
    s_cbranch_scc1 L_a_bad2
L_a_ok2:
    s_mov_b32 s14, 400000
L_poll5:
    buffer_load_dword v8, v15, s[52:55], s97 offen sc1
    s_waitcnt vmcnt(0)
    v_cmp_ne_u32 vcc, s4, v8
    s_cbranch_vccz L_pdone6
    s_sub_u32 s14, s14, 1
    s_cbranch_scc0 L_poll5
L_pdone6:
    buffer_load_dwordx4 v[88:91], v14, s[52:55], s51 offen offset:0 sc1
    buffer_load_dwordx4 v[92:95], v14, s[52:55], s51 offen offset:1024 sc1
    buffer_load_dwordx4 v[96:99], v14, s[52:55], s51 offen offset:2048 sc1
    buffer_load_dwordx4 v[100:103], v14, s[52:55], s51 offen offset:3072 sc1
    s_add_u32 s51, s51, 4096
    buffer_load_dwordx4 v[104:107], v14, s[52:55], s51 offen offset:0 sc1
    buffer_load_dwordx4 v[108:111], v14, s[52:55], s51 offen offset:1024 sc1
    buffer_load_dwordx4 v[112:115], v14, s[52:55], s51 offen offset:2048 sc1
    buffer_load_dwordx4 v[116:119], v14, s[52:55], s51 offen offset:3072 sc1
    s_add_u32 s51, s51, 4096
    buffer_load_dwordx4 v[120:123], v14, s[52:55], s51 offen offset:0 sc1
    buffer_load_dwordx4 v[124:127], v14, s[52:55], s51 offen offset:1024 sc1
    buffer_load_dwordx4 v[128:131], v14, s[52:55], s51 offen offset:2048 sc1
    buffer_load_dwordx4 v[132:135], v14, s[52:55], s51 offen offset:3072 sc1
    s_add_u32 s51, s51, 4096
    buffer_load_dwordx4 v[136:139], v14, s[52:55], s51 offen offset:0 sc1
    buffer_load_dwordx4 v[140:143], v14, s[52:55], s51 offen offset:1024 sc1
    buffer_load_dwordx4 v[144:147], v14, s[52:55], s51 offen offset:2048 sc1
    buffer_load_dwordx4 v[148:151], v14, s[52:55], s51 offen offset:3072 sc1
    s_cmp_eq_u32 s71, 1
    s_cbranch_scc1 L_a_wd
L_a_ww:
    ds_read_b32 v11, v12 offset:24
    ds_read_b64 v[4:5], v7
    s_waitcnt lgkmcnt(0)
    v_cmp_gt_u32 vcc, NSYNC_B2, v11
    s_cbranch_vccnz L_a_ww
    ds_read_b64_tr_b16 v[152:153], v4 offset:0
    ds_read_b64_tr_b16 v[154:155], v4 offset:1024
    ds_read_b64_tr_b16 v[156:157], v4 offset:2048
    ds_read_b64_tr_b16 v[158:159], v4 offset:3072
    ds_read_b64_tr_b16 v[160:161], v4 offset:4096
    ds_read_b64_tr_b16 v[162:163], v4 offset:5120
    ds_read_b64_tr_b16 v[164:165], v4 offset:6144
    ds_read_b64_tr_b16 v[166:167], v4 offset:7168
    ds_read_b64_tr_b16 v[168:169], v4 offset:9216
    ds_read_b64_tr_b16 v[170:171], v4 offset:10240
    ds_read_b64_tr_b16 v[172:173], v4 offset:11264
    ds_read_b64_tr_b16 v[174:175], v4 offset:12288
    ds_read_b64_tr_b16 v[176:177], v4 offset:13312
    ds_read_b64_tr_b16 v[178:179], v4 offset:14336
    ds_read_b64_tr_b16 v[180:181], v4 offset:15360
    ds_read_b64_tr_b16 v[182:183], v4 offset:16384
    ds_read_b64_tr_b16 v[184:185], v4 offset:18432
    ds_read_b64_tr_b16 v[186:187], v4 offset:19456
    ds_read_b64_tr_b16 v[188:189], v4 offset:20480
    ds_read_b64_tr_b16 v[190:191], v4 offset:21504
    ds_read_b64_tr_b16 v[192:193], v4 offset:22528
    ds_read_b64_tr_b16 v[194:195], v4 offset:23552
    ds_read_b64_tr_b16 v[196:197], v4 offset:24576
    ds_read_b64_tr_b16 v[198:199], v4 offset:25600
L_a_wd:
    ds_read_b64_tr_b16 v[200:201], v4 offset:27648
    ds_read_b64_tr_b16 v[202:203], v4 offset:28672
    ds_read_b64_tr_b16 v[204:205], v4 offset:29696
    ds_read_b64_tr_b16 v[206:207], v4 offset:30720
    ds_read_b64_tr_b16 v[208:209], v4 offset:31744
    ds_read_b64_tr_b16 v[210:211], v4 offset:32768
    ds_read_b64_tr_b16 v[212:213], v4 offset:33792
    ds_read_b64_tr_b16 v[214:215], v4 offset:34816
    ds_read_b32 v11, v10 offset:48
    ds_read_b128 v[16:19], v6 offset:0
    ds_read_b128 v[20:23], v6 offset:1024
    ds_read_b128 v[24:27], v6 offset:2048
    ds_read_b128 v[28:31], v6 offset:3072
    s_lshl2_add_u32 s9, s2, s15
    s_cmp_eq_u32 s9, 0
    s_cbranch_scc0 L_a_noep
    v_mov_b32 v8, 0
    v_mov_b32 v9, s4
    s_mov_b64 exec, 1
    buffer_store_dword v9, v8, s[52:55], s9 offen sc1
    s_mov_b64 exec, -1
L_a_noep:
    s_waitcnt vmcnt(15) lgkmcnt(15)
    v_mfma_f32_32x32x16_bf16 v[48:63], v[88:91], v[152:155], 0
    s_waitcnt vmcnt(14) lgkmcnt(15)
    v_mfma_f32_32x32x16_bf16 v[48:63], v[92:95], v[156:159], v[48:63]
    s_waitcnt vmcnt(13) lgkmcnt(15)
    v_mfma_f32_32x32x16_bf16 v[48:63], v[96:99], v[160:163], v[48:63]
    s_waitcnt vmcnt(12) lgkmcnt(15)
    v_mfma_f32_32x32x16_bf16 v[48:63], v[100:103], v[164:167], v[48:63]
    s_waitcnt vmcnt(11) lgkmcnt(15)
    v_mfma_f32_32x32x16_bf16 v[48:63], v[104:107], v[168:171], v[48:63]
    s_waitcnt vmcnt(10) lgkmcnt(15)
    v_mfma_f32_32x32x16_bf16 v[48:63], v[108:111], v[172:175], v[48:63]
    s_waitcnt vmcnt(9) lgkmcnt(15)
    v_mfma_f32_32x32x16_bf16 v[48:63], v[112:115], v[176:179], v[48:63]
    s_waitcnt vmcnt(8) lgkmcnt(15)
    v_mfma_f32_32x32x16_bf16 v[48:63], v[116:119], v[180:183], v[48:63]
    s_waitcnt vmcnt(7) lgkmcnt(15)
    v_mfma_f32_32x32x16_bf16 v[48:63], v[120:123], v[184:187], v[48:63]
    s_waitcnt vmcnt(6) lgkmcnt(15)
    v_mfma_f32_32x32x16_bf16 v[48:63], v[124:127], v[188:191], v[48:63]
    s_waitcnt vmcnt(5) lgkmcnt(15)
    v_mfma_f32_32x32x16_bf16 v[48:63], v[128:131], v[192:195], v[48:63]
    s_waitcnt vmcnt(4) lgkmcnt(13)
    v_mfma_f32_32x32x16_bf16 v[48:63], v[132:135], v[196:199], v[48:63]
    s_waitcnt vmcnt(3) lgkmcnt(11)
    v_mfma_f32_32x32x16_bf16 v[48:63], v[136:139], v[200:203], v[48:63]
    s_waitcnt vmcnt(2) lgkmcnt(9)
    v_mfma_f32_32x32x16_bf16 v[48:63], v[140:143], v[204:207], v[48:63]
    s_waitcnt vmcnt(1) lgkmcnt(7)
    v_mfma_f32_32x32x16_bf16 v[48:63], v[144:147], v[208:211], v[48:63]
    s_waitcnt vmcnt(0) lgkmcnt(5)
    v_mfma_f32_32x32x16_bf16 v[48:63], v[148:151], v[212:215], v[48:63]
    s_waitcnt lgkmcnt(0)
    v_cmp_eq_u32 vcc, 0, v11
    s_cbranch_vccz L_a_hok
L_a_hw:
    ds_read_b32 v11, v10 offset:48
    ds_read_b128 v[16:19], v6 offset:0
    ds_read_b128 v[20:23], v6 offset:1024
    ds_read_b128 v[24:27], v6 offset:2048
    ds_read_b128 v[28:31], v6 offset:3072
    s_waitcnt lgkmcnt(0)
    v_cmp_eq_u32 vcc, 0, v11
    s_cbranch_vccnz L_a_hw
L_a_hok:
    s_nop 8
    v_pk_add_f32 v[48:49], v[48:49], v[16:17]
    s_add_u32 s10, s12, 0
    buffer_store_dword v48, v5, s[60:63], s10 offen nt
    s_add_u32 s10, s12, 4096
    buffer_store_dword v49, v5, s[60:63], s10 offen nt
    v_pk_add_f32 v[50:51], v[50:51], v[18:19]
    s_add_u32 s10, s12, 8192
    buffer_store_dword v50, v5, s[60:63], s10 offen nt
    s_add_u32 s10, s12, 12288
    buffer_store_dword v51, v5, s[60:63], s10 offen nt
    v_pk_add_f32 v[52:53], v[52:53], v[20:21]
    s_add_u32 s10, s12, 32768
    buffer_store_dword v52, v5, s[60:63], s10 offen nt
    s_add_u32 s10, s12, 36864
    buffer_store_dword v53, v5, s[60:63], s10 offen nt
    v_pk_add_f32 v[54:55], v[54:55], v[22:23]
    s_add_u32 s10, s12, 40960
    buffer_store_dword v54, v5, s[60:63], s10 offen nt
    s_add_u32 s10, s12, 45056
    buffer_store_dword v55, v5, s[60:63], s10 offen nt
    v_pk_add_f32 v[56:57], v[56:57], v[24:25]
    s_add_u32 s10, s12, 65536
    buffer_store_dword v56, v5, s[60:63], s10 offen nt
    s_add_u32 s10, s12, 69632
    buffer_store_dword v57, v5, s[60:63], s10 offen nt
    v_pk_add_f32 v[58:59], v[58:59], v[26:27]
    s_add_u32 s10, s12, 73728
    buffer_store_dword v58, v5, s[60:63], s10 offen nt
    s_add_u32 s10, s12, 77824
    buffer_store_dword v59, v5, s[60:63], s10 offen nt
    v_pk_add_f32 v[60:61], v[60:61], v[28:29]
    s_add_u32 s10, s12, 98304
    buffer_store_dword v60, v5, s[60:63], s10 offen nt
    s_add_u32 s10, s12, 102400
    buffer_store_dword v61, v5, s[60:63], s10 offen nt
    v_pk_add_f32 v[62:63], v[62:63], v[30:31]
    s_add_u32 s10, s12, 106496
    buffer_store_dword v62, v5, s[60:63], s10 offen nt
    s_add_u32 s10, s12, 110592
    buffer_store_dword v63, v5, s[60:63], s10 offen nt
    s_branch L_end
L_h2:
    s_setprio 2
L_wc11:
    ds_read_b32 v30, v2 offset:16
    s_waitcnt lgkmcnt(0)
    v_cmp_gt_u32 vcc, 4, v30
    s_cbranch_vccnz L_wc11
    ds_read_b32 v30, v2 offset:44
    s_setprio 0
    s_add_u32 m0, s51, 73728
    s_add_u32 s11, s20, 0
    buffer_load_dwordx4 v120, s[60:63], s11 offen lds
    s_add_u32 m0, s51, 77824
    s_add_u32 s11, s20, 16384
    buffer_load_dwordx4 v120, s[60:63], s11 offen lds
    s_add_u32 m0, s51, 81920
    s_add_u32 s11, s20, 0
    buffer_load_dwordx4 v120, s[64:67], s11 offen lds
    s_add_u32 m0, s51, 86016
    s_add_u32 s11, s20, 16384
    buffer_load_dwordx4 v120, s[64:67], s11 offen lds
    buffer_load_dwordx4 v[128:131], v8, s[56:59], s16 offen offset:0
    buffer_load_dwordx4 v[132:135], v9, s[56:59], s16 offen offset:0
    buffer_load_dwordx4 v[136:139], v8, s[56:59], s16 offen offset:64
    buffer_load_dwordx4 v[140:143], v9, s[56:59], s16 offen offset:64
    buffer_load_dwordx4 v[144:147], v8, s[56:59], s16 offen offset:128
    s_add_u32 m0, s51, 90112
    s_add_u32 s11, s21, 0
    buffer_load_dwordx4 v120, s[60:63], s11 offen lds
    buffer_load_dwordx4 v[148:151], v9, s[56:59], s16 offen offset:128
    s_add_u32 m0, s51, 94208
    s_add_u32 s11, s21, 16384
    buffer_load_dwordx4 v120, s[60:63], s11 offen lds
    s_waitcnt vmcnt(8)
    s_mov_b64 exec, 1
    ds_add_u32 v2, v3 offset:40
    s_mov_b64 exec, -1
    buffer_load_dwordx4 v[152:155], v8, s[56:59], s16 offen offset:192
    s_add_u32 m0, s51, 98304
    s_add_u32 s11, s21, 0
    buffer_load_dwordx4 v120, s[64:67], s11 offen lds
    buffer_load_dwordx4 v[156:159], v9, s[56:59], s16 offen offset:192
    s_add_u32 m0, s51, 102400
    s_add_u32 s11, s21, 16384
    buffer_load_dwordx4 v120, s[64:67], s11 offen lds
    s_waitcnt vmcnt(10)
    ds_write_b128 v10, v[128:131]
    ds_write_b128 v10, v[132:135] offset:1024
    ds_read_b128 v[128:131], v11
    ds_read_b128 v[132:135], v12
    s_waitcnt vmcnt(8)
    ds_write_b128 v10, v[136:139]
    ds_write_b128 v10, v[140:143] offset:1024
    ds_read_b128 v[136:139], v11
    ds_read_b128 v[140:143], v12
    s_setprio 2
L_wc12:
    ds_read_b32 v31, v2 offset:40
    s_waitcnt lgkmcnt(0)
    v_cmp_gt_u32 vcc, 4, v31
    s_cbranch_vccnz L_wc12
    v_readfirstlane_b32 s70, v30
    s_setprio 0
    ds_read_b128 v[64:67], v112 offset:0
    ds_read_b128 v[68:71], v112 offset:8192
    ds_read_b128 v[72:75], v113 offset:0
    ds_read_b128 v[76:79], v113 offset:8192
    ds_read_b128 v[80:83], v114 offset:0
    ds_read_b128 v[84:87], v114 offset:8192
    s_waitcnt lgkmcnt(4)
    v_mfma_f32_32x32x16_bf16 v[32:47], v[128:131], v[64:67], 0
    ds_read_b128 v[88:91], v115 offset:0
    ds_read_b128 v[92:95], v115 offset:8192
    buffer_load_dwordx4 v[160:163], v8, s[56:59], s17 offen offset:0
    v_mfma_f32_32x32x16_bf16 v[48:63], v[128:131], v[68:71], 0
    buffer_load_dwordx4 v[164:167], v9, s[56:59], s17 offen offset:0
    s_waitcnt vmcnt(7)
    ds_write_b128 v10, v[144:147]
    s_waitcnt lgkmcnt(5)
    v_mfma_f32_32x32x16_bf16 v[32:47], v[132:135], v[72:75], v[32:47]
    ds_read_b128 v[64:67], v116 offset:0
    ds_read_b128 v[68:71], v116 offset:8192
    buffer_load_dwordx4 v[168:171], v8, s[56:59], s17 offen offset:64
    v_mfma_f32_32x32x16_bf16 v[48:63], v[132:135], v[76:79], v[48:63]
    buffer_load_dwordx4 v[172:175], v9, s[56:59], s17 offen offset:64
    ds_write_b128 v10, v[148:151] offset:1024
    ds_read_b128 v[144:147], v11
    ds_read_b128 v[148:151], v12
    s_waitcnt lgkmcnt(8)
    v_mfma_f32_32x32x16_bf16 v[32:47], v[136:139], v[80:83], v[32:47]
    s_waitcnt vmcnt(4)
    s_mov_b64 exec, 1
    ds_add_u32 v2, v3 offset:4
    s_mov_b64 exec, -1
    ds_read_b128 v[72:75], v117 offset:0
    ds_read_b128 v[76:79], v117 offset:8192
    buffer_load_dwordx4 v[176:179], v8, s[56:59], s17 offen offset:128
    v_mfma_f32_32x32x16_bf16 v[48:63], v[136:139], v[84:87], v[48:63]
    s_add_u32 m0, s51, 106496
    s_add_u32 s11, s22, 0
    buffer_load_dwordx4 v120, s[60:63], s11 offen lds
    ds_write_b128 v10, v[152:155]
    s_waitcnt lgkmcnt(10)
    v_mfma_f32_32x32x16_bf16 v[32:47], v[140:143], v[88:91], v[32:47]
    ds_read_b128 v[80:83], v118 offset:0
    ds_read_b128 v[84:87], v118 offset:8192
    buffer_load_dwordx4 v[180:183], v9, s[56:59], s17 offen offset:128
    v_mfma_f32_32x32x16_bf16 v[48:63], v[140:143], v[92:95], v[48:63]
    s_add_u32 m0, s51, 110592
    s_add_u32 s11, s22, 16384
    buffer_load_dwordx4 v120, s[60:63], s11 offen lds
    ds_write_b128 v10, v[156:159] offset:1024
    ds_read_b128 v[152:155], v11
    ds_read_b128 v[156:159], v12
    s_waitcnt lgkmcnt(9)
    v_mfma_f32_32x32x16_bf16 v[32:47], v[144:147], v[64:67], v[32:47]
    ds_read_b32 v31, v2 offset:4
    ds_read_b128 v[88:91], v119 offset:0
    ds_read_b128 v[92:95], v119 offset:8192
    buffer_load_dwordx4 v[184:187], v8, s[56:59], s17 offen offset:192
    v_mfma_f32_32x32x16_bf16 v[48:63], v[144:147], v[68:71], v[48:63]
    s_add_u32 m0, s51, 114688
    s_add_u32 s11, s22, 0
    buffer_load_dwordx4 v120, s[64:67], s11 offen lds
    s_waitcnt vmcnt(8)
    ds_write_b128 v10, v[160:163]
    s_waitcnt lgkmcnt(10)
    v_mfma_f32_32x32x16_bf16 v[32:47], v[148:151], v[72:75], v[32:47]
    s_waitcnt lgkmcnt(3)
    s_setprio 2
    v_cmp_gt_u32 vcc, 4, v31
    s_cbranch_vccz L_bk13
L_wc14:
    ds_read_b32 v31, v2 offset:4
    s_waitcnt lgkmcnt(0)
    v_cmp_gt_u32 vcc, 4, v31
    s_cbranch_vccnz L_wc14
L_bk13:
    s_setprio 0
    ds_read_b128 v[64:67], v112 offset:16384
    ds_read_b128 v[68:71], v112 offset:24576
    buffer_load_dwordx4 v[188:191], v9, s[56:59], s17 offen offset:192
    v_mfma_f32_32x32x16_bf16 v[48:63], v[148:151], v[76:79], v[48:63]
    s_add_u32 m0, s51, 118784
    s_add_u32 s11, s22, 16384
    buffer_load_dwordx4 v120, s[64:67], s11 offen lds
    ds_write_b128 v10, v[164:167] offset:1024
    ds_read_b128 v[160:163], v11
    ds_read_b128 v[164:167], v12
    v_mfma_f32_32x32x16_bf16 v[32:47], v[152:155], v[80:83], v[32:47]
    ds_read_b128 v[72:75], v113 offset:16384
    ds_read_b128 v[76:79], v113 offset:24576
    buffer_load_dwordx4 v[192:195], v8, s[56:59], s18 offen offset:0
    v_mfma_f32_32x32x16_bf16 v[48:63], v[152:155], v[84:87], v[48:63]
    buffer_load_dwordx4 v[196:199], v9, s[56:59], s18 offen offset:0
    s_waitcnt vmcnt(10)
    ds_write_b128 v10, v[168:171]
    s_waitcnt lgkmcnt(9)
    v_mfma_f32_32x32x16_bf16 v[32:47], v[156:159], v[88:91], v[32:47]
    ds_read_b128 v[80:83], v114 offset:16384
    ds_read_b128 v[84:87], v114 offset:24576
    buffer_load_dwordx4 v[200:203], v8, s[56:59], s18 offen offset:64
    v_mfma_f32_32x32x16_bf16 v[48:63], v[156:159], v[92:95], v[48:63]
    buffer_load_dwordx4 v[204:207], v9, s[56:59], s18 offen offset:64
    ds_write_b128 v10, v[172:175] offset:1024
    ds_read_b128 v[168:171], v11
    ds_read_b128 v[172:175], v12
    s_waitcnt lgkmcnt(8)
    v_mfma_f32_32x32x16_bf16 v[32:47], v[160:163], v[64:67], v[32:47]
    ds_read_b128 v[88:91], v115 offset:16384
    ds_read_b128 v[92:95], v115 offset:24576
    buffer_load_dwordx4 v[208:211], v8, s[56:59], s18 offen offset:128
    v_mfma_f32_32x32x16_bf16 v[48:63], v[160:163], v[68:71], v[48:63]
    s_add_u32 m0, s51, 122880
    s_add_u32 s11, s23, 0
    buffer_load_dwordx4 v120, s[60:63], s11 offen lds
    s_waitcnt vmcnt(11)
    ds_write_b128 v10, v[176:179]
    s_waitcnt lgkmcnt(9)
    v_mfma_f32_32x32x16_bf16 v[32:47], v[164:167], v[72:75], v[32:47]
    ds_read_b128 v[64:67], v116 offset:16384
    ds_read_b128 v[68:71], v116 offset:24576
    buffer_load_dwordx4 v[212:215], v9, s[56:59], s18 offen offset:128
    v_mfma_f32_32x32x16_bf16 v[48:63], v[164:167], v[76:79], v[48:63]
    s_add_u32 m0, s51, 126976
    s_add_u32 s11, s23, 16384
    buffer_load_dwordx4 v120, s[60:63], s11 offen lds
    ds_write_b128 v10, v[180:183] offset:1024
    ds_read_b128 v[176:179], v11
    ds_read_b128 v[180:183], v12
    s_waitcnt lgkmcnt(8)
    v_mfma_f32_32x32x16_bf16 v[32:47], v[168:171], v[80:83], v[32:47]
    s_waitcnt vmcnt(8)
    s_mov_b64 exec, 1
    ds_add_u32 v2, v3 offset:8
    s_mov_b64 exec, -1
    ds_read_b128 v[72:75], v117 offset:16384
    ds_read_b128 v[76:79], v117 offset:24576
    buffer_load_dwordx4 v[216:219], v8, s[56:59], s18 offen offset:192
    v_mfma_f32_32x32x16_bf16 v[48:63], v[168:171], v[84:87], v[48:63]
    s_add_u32 m0, s51, 131072
    s_add_u32 s11, s23, 0
    buffer_load_dwordx4 v120, s[64:67], s11 offen lds
    ds_write_b128 v10, v[184:187]
    s_waitcnt lgkmcnt(10)
    v_mfma_f32_32x32x16_bf16 v[32:47], v[172:175], v[88:91], v[32:47]
    ds_read_b128 v[80:83], v118 offset:16384
    ds_read_b128 v[84:87], v118 offset:24576
    buffer_load_dwordx4 v[220:223], v9, s[56:59], s18 offen offset:192
    v_mfma_f32_32x32x16_bf16 v[48:63], v[172:175], v[92:95], v[48:63]
    s_add_u32 m0, s51, 135168
    s_add_u32 s11, s23, 16384
    buffer_load_dwordx4 v120, s[64:67], s11 offen lds
    ds_write_b128 v10, v[188:191] offset:1024
    ds_read_b128 v[184:187], v11
    ds_read_b128 v[188:191], v12
    s_waitcnt lgkmcnt(9)
    v_mfma_f32_32x32x16_bf16 v[32:47], v[176:179], v[64:67], v[32:47]
    ds_read_b32 v31, v2 offset:8
    ds_read_b128 v[88:91], v119 offset:16384
    ds_read_b128 v[92:95], v119 offset:24576
    buffer_load_dwordx4 v[224:227], v8, s[56:59], s19 offen offset:0
    v_mfma_f32_32x32x16_bf16 v[48:63], v[176:179], v[68:71], v[48:63]
    buffer_load_dwordx4 v[228:231], v9, s[56:59], s19 offen offset:0
    s_waitcnt vmcnt(12)
    ds_write_b128 v10, v[192:195]
    s_waitcnt lgkmcnt(10)
    v_mfma_f32_32x32x16_bf16 v[32:47], v[180:183], v[72:75], v[32:47]
    s_waitcnt lgkmcnt(3)
    s_setprio 2
    v_cmp_gt_u32 vcc, 4, v31
    s_cbranch_vccz L_bk15
L_wc16:
    ds_read_b32 v31, v2 offset:8
    s_waitcnt lgkmcnt(0)
    v_cmp_gt_u32 vcc, 4, v31
    s_cbranch_vccnz L_wc16
L_bk15:
    s_setprio 0
    ds_read_b128 v[64:67], v112 offset:32768
    ds_read_b128 v[68:71], v112 offset:40960
    buffer_load_dwordx4 v[232:235], v8, s[56:59], s19 offen offset:64
    v_mfma_f32_32x32x16_bf16 v[48:63], v[180:183], v[76:79], v[48:63]
    buffer_load_dwordx4 v[236:239], v9, s[56:59], s19 offen offset:64
    ds_write_b128 v10, v[196:199] offset:1024
    ds_read_b128 v[192:195], v11
    ds_read_b128 v[196:199], v12
    v_mfma_f32_32x32x16_bf16 v[32:47], v[184:187], v[80:83], v[32:47]
    ds_read_b128 v[72:75], v113 offset:32768
    ds_read_b128 v[76:79], v113 offset:40960
    buffer_load_dwordx4 v[240:243], v8, s[56:59], s19 offen offset:128
    v_mfma_f32_32x32x16_bf16 v[48:63], v[184:187], v[84:87], v[48:63]
    buffer_load_dwordx4 v[244:247], v9, s[56:59], s19 offen offset:128
    s_waitcnt vmcnt(14)
    ds_write_b128 v10, v[200:203]
    s_waitcnt lgkmcnt(9)
    v_mfma_f32_32x32x16_bf16 v[32:47], v[188:191], v[88:91], v[32:47]
    ds_read_b128 v[80:83], v114 offset:32768
    ds_read_b128 v[84:87], v114 offset:40960
    buffer_load_dwordx4 v[248:251], v8, s[56:59], s19 offen offset:192
    v_mfma_f32_32x32x16_bf16 v[48:63], v[188:191], v[92:95], v[48:63]
    buffer_load_dwordx4 v[252:255], v9, s[56:59], s19 offen offset:192
    ds_write_b128 v10, v[204:207] offset:1024
    ds_read_b128 v[200:203], v11
    ds_read_b128 v[204:207], v12
    s_waitcnt lgkmcnt(8)
    v_mfma_f32_32x32x16_bf16 v[32:47], v[192:195], v[64:67], v[32:47]
    ds_read_b128 v[88:91], v115 offset:32768
    ds_read_b128 v[92:95], v115 offset:40960
    v_mfma_f32_32x32x16_bf16 v[48:63], v[192:195], v[68:71], v[48:63]
    s_waitcnt vmcnt(13)
    ds_write_b128 v10, v[208:211]
    s_waitcnt lgkmcnt(9)
    v_mfma_f32_32x32x16_bf16 v[32:47], v[196:199], v[72:75], v[32:47]
    ds_read_b128 v[64:67], v116 offset:32768
    ds_read_b128 v[68:71], v116 offset:40960
    v_mfma_f32_32x32x16_bf16 v[48:63], v[196:199], v[76:79], v[48:63]
    ds_write_b128 v10, v[212:215] offset:1024
    ds_read_b128 v[208:211], v11
    ds_read_b128 v[212:215], v12
    s_waitcnt lgkmcnt(8)
    v_mfma_f32_32x32x16_bf16 v[32:47], v[200:203], v[80:83], v[32:47]
    s_waitcnt vmcnt(8)
    s_mov_b64 exec, 1
    ds_add_u32 v2, v3 offset:32
    s_mov_b64 exec, -1
    ds_read_b128 v[72:75], v117 offset:32768
    ds_read_b128 v[76:79], v117 offset:40960
    v_mfma_f32_32x32x16_bf16 v[48:63], v[200:203], v[84:87], v[48:63]
    ds_write_b128 v10, v[216:219]
    s_waitcnt lgkmcnt(10)
    v_mfma_f32_32x32x16_bf16 v[32:47], v[204:207], v[88:91], v[32:47]
    ds_read_b128 v[80:83], v118 offset:32768
    ds_read_b128 v[84:87], v118 offset:40960
    global_load_dword v137, v17, s[98:99]
    v_mfma_f32_32x32x16_bf16 v[48:63], v[204:207], v[92:95], v[48:63]
    ds_write_b128 v10, v[220:223] offset:1024
    ds_read_b128 v[216:219], v11
    ds_read_b128 v[220:223], v12
    s_waitcnt lgkmcnt(9)
    v_mfma_f32_32x32x16_bf16 v[32:47], v[208:211], v[64:67], v[32:47]
    ds_read_b32 v31, v2 offset:32
    ds_read_b128 v[88:91], v119 offset:32768
    ds_read_b128 v[92:95], v119 offset:40960
    v_mfma_f32_32x32x16_bf16 v[48:63], v[208:211], v[68:71], v[48:63]
    s_waitcnt vmcnt(7)
    ds_write_b128 v10, v[224:227]
    s_waitcnt lgkmcnt(10)
    v_mfma_f32_32x32x16_bf16 v[32:47], v[212:215], v[72:75], v[32:47]
    s_waitcnt lgkmcnt(3)
    s_setprio 2
    v_cmp_gt_u32 vcc, 4, v31
    s_cbranch_vccz L_bk17
L_wc18:
    ds_read_b32 v31, v2 offset:32
    s_waitcnt lgkmcnt(0)
    v_cmp_gt_u32 vcc, 4, v31
    s_cbranch_vccnz L_wc18
L_bk17:
    s_setprio 0
    ds_read_b128 v[64:67], v112 offset:49152
    ds_read_b128 v[68:71], v112 offset:57344
    global_load_dword v136, v18, s[24:25]
    v_mfma_f32_32x32x16_bf16 v[48:63], v[212:215], v[76:79], v[48:63]
    ds_write_b128 v10, v[228:231] offset:1024
    ds_read_b128 v[224:227], v11
    ds_read_b128 v[228:231], v12
    v_mfma_f32_32x32x16_bf16 v[32:47], v[216:219], v[80:83], v[32:47]
    ds_read_b128 v[72:75], v113 offset:49152
    ds_read_b128 v[76:79], v113 offset:57344
    v_mfma_f32_32x32x16_bf16 v[48:63], v[216:219], v[84:87], v[48:63]
    s_waitcnt vmcnt(6)
    ds_write_b128 v10, v[232:235]
    s_waitcnt lgkmcnt(9)
    v_mfma_f32_32x32x16_bf16 v[32:47], v[220:223], v[88:91], v[32:47]
    ds_read_b128 v[80:83], v114 offset:49152
    ds_read_b128 v[84:87], v114 offset:57344
    v_mfma_f32_32x32x16_bf16 v[48:63], v[220:223], v[92:95], v[48:63]
    ds_write_b128 v10, v[236:239] offset:1024
    ds_read_b128 v[232:235], v11
    ds_read_b128 v[236:239], v12
    s_waitcnt lgkmcnt(8)
    v_mfma_f32_32x32x16_bf16 v[32:47], v[224:227], v[64:67], v[32:47]
    ds_read_b128 v[88:91], v115 offset:49152
    ds_read_b128 v[92:95], v115 offset:57344
    v_mfma_f32_32x32x16_bf16 v[48:63], v[224:227], v[68:71], v[48:63]
    s_waitcnt vmcnt(4)
    ds_write_b128 v10, v[240:243]
    s_waitcnt lgkmcnt(9)
    v_mfma_f32_32x32x16_bf16 v[32:47], v[228:231], v[72:75], v[32:47]
    ds_read_b128 v[64:67], v116 offset:49152
    ds_read_b128 v[68:71], v116 offset:57344
    v_mfma_f32_32x32x16_bf16 v[48:63], v[228:231], v[76:79], v[48:63]
    ds_write_b128 v10, v[244:247] offset:1024
    ds_read_b128 v[240:243], v11
    ds_read_b128 v[244:247], v12
    s_waitcnt lgkmcnt(8)
    v_mfma_f32_32x32x16_bf16 v[32:47], v[232:235], v[80:83], v[32:47]
    ds_read_b128 v[72:75], v117 offset:49152
    ds_read_b128 v[76:79], v117 offset:57344
    v_mfma_f32_32x32x16_bf16 v[48:63], v[232:235], v[84:87], v[48:63]
    s_waitcnt vmcnt(2)
    ds_write_b128 v10, v[248:251]
    s_waitcnt lgkmcnt(9)
    v_mfma_f32_32x32x16_bf16 v[32:47], v[236:239], v[88:91], v[32:47]
    ds_read_b128 v[80:83], v118 offset:49152
    ds_read_b128 v[84:87], v118 offset:57344
    s_cmp_eq_u32 s70, 1
    s_cbranch_scc0 L_h_nopt
    s_add_u32 s72, s15, 4
    s_and_b32 s9, s72, 1
    s_lshl_b32 s10, s5, 1
    s_add_u32 s9, s9, s10
    s_lshl_b32 s9, s9, 2
    s_lshr_b32 s10, s72, 1
    s_add_u32 s9, s9, s10
    s_lshl_b32 s9, s9, 3
    s_add_u32 s9, s9, s6
    s_lshl_b32 s10, s9, 10
    s_add_u32 s10, s10, 1048576
    s_lshl_b32 s9, s9, 7
    s_add_u32 s9, s9, 524288
    buffer_load_dwordx4 v[144:147], v6, s[52:55], s10 offen offset:0 sc1
    s_mov_b64 exec, 0xff
    buffer_load_dwordx4 v[144:147], v6, s[52:55], s9 offen offset:0 sc1
    s_mov_b64 exec, -1
L_h_nopt:
    v_mfma_f32_32x32x16_bf16 v[48:63], v[236:239], v[92:95], v[48:63]
    ds_write_b128 v10, v[252:255] offset:1024
    ds_read_b128 v[248:251], v11
    ds_read_b128 v[252:255], v12
    s_waitcnt lgkmcnt(8)
    v_mfma_f32_32x32x16_bf16 v[32:47], v[240:243], v[64:67], v[32:47]
    ds_read_b128 v[88:91], v119 offset:49152
    ds_read_b128 v[92:95], v119 offset:57344
    buffer_load_dwordx4 v[128:131], v29, s[56:59], s13 offen
    buffer_load_dwordx4 v[132:135], v29, s[56:59], s13 offen offset:32
    v_mfma_f32_32x32x16_bf16 v[48:63], v[240:243], v[68:71], v[48:63]
    s_waitcnt lgkmcnt(8)
    v_mfma_f32_32x32x16_bf16 v[32:47], v[244:247], v[72:75], v[32:47]
    v_mfma_f32_32x32x16_bf16 v[48:63], v[244:247], v[76:79], v[48:63]
    s_waitcnt lgkmcnt(2)
    v_mfma_f32_32x32x16_bf16 v[32:47], v[248:251], v[80:83], v[32:47]
    v_mfma_f32_32x32x16_bf16 v[48:63], v[248:251], v[84:87], v[48:63]
    s_waitcnt lgkmcnt(0)
    v_mfma_f32_32x32x16_bf16 v[32:47], v[252:255], v[88:91], v[32:47]
    v_mfma_f32_32x32x16_bf16 v[48:63], v[252:255], v[92:95], v[48:63]
    s_setprio 2
    s_mov_b32 s60, s36
    s_and_b32 s61, s37, 0xffff
    s_mov_b32 s62, 524288
    s_mov_b32 s63, 0x20000
    s_mov_b32 s64, s38
    s_and_b32 s65, s39, 0xffff
    s_mov_b32 s66, 524288
    s_mov_b32 s67, 0x20000
    s_mov_b32 s56, s24
    s_and_b32 s57, s25, 0xffff
    s_mov_b32 s58, 524288
    s_mov_b32 s59, 0x20000
    s_lshl_b32 s12, s100, 16
    s_lshl_b32 s10, s15, 13
    s_add_u32 s12, s12, s10
    s_mul_i32 s10, s15, 8320
    v_pk_mul_f32 v[64:65], v[26:27], v[32:33] op_sel:[0,0] op_sel_hi:[1,0]
    v_pk_mul_f32 v[66:67], v[26:27], v[32:33] op_sel:[0,1] op_sel_hi:[1,1]
    v_pk_mul_f32 v[68:69], v[26:27], v[34:35] op_sel:[0,0] op_sel_hi:[1,0]
    v_pk_fma_f32 v[64:65], v[26:27], v[48:49], v[64:65] op_sel:[1,0,0] op_sel_hi:[0,0,1] neg_lo:[1,0,0]
    v_pk_fma_f32 v[66:67], v[26:27], v[48:49], v[66:67] op_sel:[1,1,0] op_sel_hi:[0,1,1] neg_lo:[1,0,0]
    v_pk_fma_f32 v[68:69], v[26:27], v[50:51], v[68:69] op_sel:[1,0,0] op_sel_hi:[0,0,1] neg_lo:[1,0,0]
    v_pk_fma_f32 v[30:31], v[20:21], v[64:65], v[66:67] op_sel:[0,0,0] op_sel_hi:[0,1,1]
    v_pk_mul_f32 v[70:71], v[26:27], v[34:35] op_sel:[0,1] op_sel_hi:[1,1]
    v_pk_fma_f32 v[30:31], v[20:21], v[64:65], v[30:31] op_sel:[1,1,0] op_sel_hi:[1,0,1] neg_lo:[1,0,0]
    v_pk_fma_f32 v[70:71], v[26:27], v[50:51], v[70:71] op_sel:[1,1,0] op_sel_hi:[0,1,1] neg_lo:[1,0,0]
    v_pk_fma_f32 v[8:9], v[20:21], v[30:31], v[68:69] op_sel:[0,0,0] op_sel_hi:[0,1,1]
    v_pk_mul_f32 v[72:73], v[26:27], v[36:37] op_sel:[0,0] op_sel_hi:[1,0]
    v_pk_fma_f32 v[8:9], v[20:21], v[30:31], v[8:9] op_sel:[1,1,0] op_sel_hi:[1,0,1] neg_lo:[1,0,0]
    v_pk_fma_f32 v[72:73], v[26:27], v[52:53], v[72:73] op_sel:[1,0,0] op_sel_hi:[0,0,1] neg_lo:[1,0,0]
    v_pk_fma_f32 v[30:31], v[20:21], v[8:9], v[70:71] op_sel:[0,0,0] op_sel_hi:[0,1,1]
    v_pk_mul_f32 v[74:75], v[26:27], v[36:37] op_sel:[0,1] op_sel_hi:[1,1]
    v_pk_fma_f32 v[30:31], v[20:21], v[8:9], v[30:31] op_sel:[1,1,0] op_sel_hi:[1,0,1] neg_lo:[1,0,0]
    v_pk_fma_f32 v[74:75], v[26:27], v[52:53], v[74:75] op_sel:[1,1,0] op_sel_hi:[0,1,1] neg_lo:[1,0,0]
    v_pk_fma_f32 v[8:9], v[20:21], v[30:31], v[72:73] op_sel:[0,0,0] op_sel_hi:[0,1,1]
    v_pk_mul_f32 v[76:77], v[26:27], v[38:39] op_sel:[0,0] op_sel_hi:[1,0]
    v_pk_fma_f32 v[8:9], v[20:21], v[30:31], v[8:9] op_sel:[1,1,0] op_sel_hi:[1,0,1] neg_lo:[1,0,0]
    v_pk_fma_f32 v[76:77], v[26:27], v[54:55], v[76:77] op_sel:[1,0,0] op_sel_hi:[0,0,1] neg_lo:[1,0,0]
    v_pk_fma_f32 v[30:31], v[20:21], v[8:9], v[74:75] op_sel:[0,0,0] op_sel_hi:[0,1,1]
    v_pk_mul_f32 v[78:79], v[26:27], v[38:39] op_sel:[0,1] op_sel_hi:[1,1]
    v_pk_fma_f32 v[30:31], v[20:21], v[8:9], v[30:31] op_sel:[1,1,0] op_sel_hi:[1,0,1] neg_lo:[1,0,0]
    v_pk_fma_f32 v[78:79], v[26:27], v[54:55], v[78:79] op_sel:[1,1,0] op_sel_hi:[0,1,1] neg_lo:[1,0,0]
    v_pk_fma_f32 v[8:9], v[20:21], v[30:31], v[76:77] op_sel:[0,0,0] op_sel_hi:[0,1,1]
    v_pk_mul_f32 v[80:81], v[26:27], v[40:41] op_sel:[0,0] op_sel_hi:[1,0]
    v_pk_fma_f32 v[8:9], v[20:21], v[30:31], v[8:9] op_sel:[1,1,0] op_sel_hi:[1,0,1] neg_lo:[1,0,0]
    v_pk_fma_f32 v[80:81], v[26:27], v[56:57], v[80:81] op_sel:[1,0,0] op_sel_hi:[0,0,1] neg_lo:[1,0,0]
    v_pk_fma_f32 v[30:31], v[20:21], v[8:9], v[78:79] op_sel:[0,0,0] op_sel_hi:[0,1,1]
    v_pk_mul_f32 v[82:83], v[26:27], v[40:41] op_sel:[0,1] op_sel_hi:[1,1]
    v_pk_fma_f32 v[30:31], v[20:21], v[8:9], v[30:31] op_sel:[1,1,0] op_sel_hi:[1,0,1] neg_lo:[1,0,0]
    v_pk_fma_f32 v[82:83], v[26:27], v[56:57], v[82:83] op_sel:[1,1,0] op_sel_hi:[0,1,1] neg_lo:[1,0,0]
    v_pk_fma_f32 v[8:9], v[20:21], v[30:31], v[80:81] op_sel:[0,0,0] op_sel_hi:[0,1,1]
    v_pk_mul_f32 v[84:85], v[26:27], v[42:43] op_sel:[0,0] op_sel_hi:[1,0]
    v_pk_fma_f32 v[8:9], v[20:21], v[30:31], v[8:9] op_sel:[1,1,0] op_sel_hi:[1,0,1] neg_lo:[1,0,0]
    v_pk_fma_f32 v[84:85], v[26:27], v[58:59], v[84:85] op_sel:[1,0,0] op_sel_hi:[0,0,1] neg_lo:[1,0,0]
    v_pk_fma_f32 v[30:31], v[20:21], v[8:9], v[82:83] op_sel:[0,0,0] op_sel_hi:[0,1,1]
    v_pk_mul_f32 v[86:87], v[26:27], v[42:43] op_sel:[0,1] op_sel_hi:[1,1]
    v_pk_fma_f32 v[30:31], v[20:21], v[8:9], v[30:31] op_sel:[1,1,0] op_sel_hi:[1,0,1] neg_lo:[1,0,0]
    v_pk_fma_f32 v[86:87], v[26:27], v[58:59], v[86:87] op_sel:[1,1,0] op_sel_hi:[0,1,1] neg_lo:[1,0,0]
    v_pk_fma_f32 v[8:9], v[20:21], v[30:31], v[84:85] op_sel:[0,0,0] op_sel_hi:[0,1,1]
    v_pk_mul_f32 v[88:89], v[26:27], v[44:45] op_sel:[0,0] op_sel_hi:[1,0]
    v_pk_fma_f32 v[8:9], v[20:21], v[30:31], v[8:9] op_sel:[1,1,0] op_sel_hi:[1,0,1] neg_lo:[1,0,0]
    v_pk_fma_f32 v[88:89], v[26:27], v[60:61], v[88:89] op_sel:[1,0,0] op_sel_hi:[0,0,1] neg_lo:[1,0,0]
    v_pk_fma_f32 v[30:31], v[20:21], v[8:9], v[86:87] op_sel:[0,0,0] op_sel_hi:[0,1,1]
    v_pk_mul_f32 v[90:91], v[26:27], v[44:45] op_sel:[0,1] op_sel_hi:[1,1]
    v_pk_fma_f32 v[30:31], v[20:21], v[8:9], v[30:31] op_sel:[1,1,0] op_sel_hi:[1,0,1] neg_lo:[1,0,0]
    v_pk_fma_f32 v[90:91], v[26:27], v[60:61], v[90:91] op_sel:[1,1,0] op_sel_hi:[0,1,1] neg_lo:[1,0,0]
    v_pk_fma_f32 v[8:9], v[20:21], v[30:31], v[88:89] op_sel:[0,0,0] op_sel_hi:[0,1,1]
    v_pk_mul_f32 v[92:93], v[26:27], v[46:47] op_sel:[0,0] op_sel_hi:[1,0]
    v_pk_fma_f32 v[8:9], v[20:21], v[30:31], v[8:9] op_sel:[1,1,0] op_sel_hi:[1,0,1] neg_lo:[1,0,0]
    v_pk_fma_f32 v[92:93], v[26:27], v[62:63], v[92:93] op_sel:[1,0,0] op_sel_hi:[0,0,1] neg_lo:[1,0,0]
    v_pk_fma_f32 v[30:31], v[20:21], v[8:9], v[90:91] op_sel:[0,0,0] op_sel_hi:[0,1,1]
    v_pk_mul_f32 v[94:95], v[26:27], v[46:47] op_sel:[0,1] op_sel_hi:[1,1]
    v_pk_fma_f32 v[30:31], v[20:21], v[8:9], v[30:31] op_sel:[1,1,0] op_sel_hi:[1,0,1] neg_lo:[1,0,0]
    v_pk_fma_f32 v[94:95], v[26:27], v[62:63], v[94:95] op_sel:[1,1,0] op_sel_hi:[0,1,1] neg_lo:[1,0,0]
    v_pk_fma_f32 v[8:9], v[20:21], v[30:31], v[92:93] op_sel:[0,0,0] op_sel_hi:[0,1,1]
    v_pk_fma_f32 v[8:9], v[20:21], v[30:31], v[8:9] op_sel:[1,1,0] op_sel_hi:[1,0,1] neg_lo:[1,0,0]
    v_pk_fma_f32 v[30:31], v[20:21], v[8:9], v[94:95] op_sel:[0,0,0] op_sel_hi:[0,1,1]
    v_pk_fma_f32 v[30:31], v[20:21], v[8:9], v[30:31] op_sel:[1,1,0] op_sel_hi:[1,0,1] neg_lo:[1,0,0]
    ds_write_b64 v13, v[30:31]
    s_waitcnt lgkmcnt(0)
    s_add_u32 s73, s73, 4
    s_mov_b64 exec, 1
    ds_add_u32 v2, v3 offset:24
    s_mov_b64 exec, -1
L_wc19:
    ds_read_b32 v32, v2 offset:24
    s_waitcnt lgkmcnt(0)
    v_cmp_gt_u32 vcc, s73, v32
    s_cbranch_vccnz L_wc19
    ds_read_b64 v[32:33], v15 offset:0
    ds_read_b64 v[34:35], v15 offset:256
    ds_read_b64 v[36:37], v15 offset:512
    ds_read_b64 v[38:39], v15 offset:768
    ds_read_b64 v[40:41], v15 offset:1024
    ds_read_b64 v[42:43], v15 offset:1280
    ds_read_b64 v[44:45], v15 offset:1536
    ds_read_b64 v[46:47], v15 offset:1792
    s_lshl_b32 s51, s8, 13
    s_add_u32 s51, s51, 393216
    s_lshl_b32 s9, s7, 9
    s_add_u32 s9, s9, s51
    v_mov_b64 v[30:31], 0
    s_mov_b32 s14, 400000
    s_waitcnt lgkmcnt(0)
    v_mov_b64 v[8:9], v[32:33]
    s_cmp_eq_u32 s15, 0
    s_cbranch_scc1 L_h_segdone
    v_pk_fma_f32 v[30:31], v[22:23], v[8:9], v[34:35] op_sel:[0,0,0] op_sel_hi:[0,1,1]
    v_pk_fma_f32 v[30:31], v[22:23], v[8:9], v[30:31] op_sel:[1,1,0] op_sel_hi:[1,0,1] neg_lo:[1,0,0]
    v_pk_fma_f32 v[8:9], v[22:23], v[30:31], v[36:37] op_sel:[0,0,0] op_sel_hi:[0,1,1]
    v_pk_fma_f32 v[8:9], v[22:23], v[30:31], v[8:9] op_sel:[1,1,0] op_sel_hi:[1,0,1] neg_lo:[1,0,0]
    s_cmp_eq_u32 s15, 1
    s_cbranch_scc1 L_h_segdone
    v_pk_fma_f32 v[30:31], v[22:23], v[8:9], v[38:39] op_sel:[0,0,0] op_sel_hi:[0,1,1]
    v_pk_fma_f32 v[30:31], v[22:23], v[8:9], v[30:31] op_sel:[1,1,0] op_sel_hi:[1,0,1] neg_lo:[1,0,0]
    v_pk_fma_f32 v[8:9], v[22:23], v[30:31], v[40:41] op_sel:[0,0,0] op_sel_hi:[0,1,1]
    v_pk_fma_f32 v[8:9], v[22:23], v[30:31], v[8:9] op_sel:[1,1,0] op_sel_hi:[1,0,1] neg_lo:[1,0,0]
    s_cmp_eq_u32 s15, 2
    s_cbranch_scc1 L_h_segdone
    v_pk_fma_f32 v[30:31], v[22:23], v[8:9], v[42:43] op_sel:[0,0,0] op_sel_hi:[0,1,1]
    v_pk_fma_f32 v[30:31], v[22:23], v[8:9], v[30:31] op_sel:[1,1,0] op_sel_hi:[1,0,1] neg_lo:[1,0,0]
    v_pk_fma_f32 v[8:9], v[22:23], v[30:31], v[44:45] op_sel:[0,0,0] op_sel_hi:[0,1,1]
    v_pk_fma_f32 v[8:9], v[22:23], v[30:31], v[8:9] op_sel:[1,1,0] op_sel_hi:[1,0,1] neg_lo:[1,0,0]
    v_pk_fma_f32 v[48:49], v[22:23], v[8:9], v[46:47] op_sel:[0,0,0] op_sel_hi:[0,1,1]
    v_pk_fma_f32 v[48:49], v[22:23], v[8:9], v[48:49] op_sel:[1,1,0] op_sel_hi:[1,0,1] neg_lo:[1,0,0]
    v_mov_b32 v50, v49
    v_mov_b32 v49, s4
    v_mov_b32 v51, s4
    s_mov_b32 exec_hi, 0
    buffer_store_dwordx4 v[48:51], v14, s[52:55], s9 offen sc1
    s_mov_b64 exec, -1
L_h_segdone:
    s_mov_b32 s68, 0
    s_mov_b32 s69, -1
    v_cndmask_b32 v30, v30, v8, s[68:69]
    v_cndmask_b32 v31, v31, v9, s[68:69]
    s_mov_b32 s71, 0
L_rl20:
    s_mul_i32 s11, s71, 1040
    s_add_u32 s11, s11, s10
    s_add_u32 m0, s11, 73728
    s_lshl_b32 s11, s71, 10
    s_add_u32 s11, s11, s12
    s_add_u32 s11, s11, 32768
    buffer_load_dwordx4 v6, s[60:63], s11 offen lds
    s_add_u32 s71, s71, 1
    s_cmp_lt_u32 s71, 8
    s_cbranch_scc1 L_rl20
    s_mov_b32 s71, 0
L_rl21:
    s_mul_i32 s11, s71, 1040
    s_add_u32 s11, s11, s10
    s_add_u32 m0, s11, 107008
    s_lshl_b32 s11, s71, 10
    s_add_u32 s11, s11, s12
    buffer_load_dwordx4 v6, s[64:67], s11 offen lds
    s_add_u32 s71, s71, 1
    s_cmp_lt_u32 s71, 8
    s_cbranch_scc1 L_rl21
    v_mov_b64 v[8:9], 0
    s_cmp_eq_u32 s7, 0
    s_cbranch_scc1 L_h_stskip
L_h_stpoll:
    buffer_load_dwordx4 v[52:55], v102, s[52:55], s51 offen sc1
    buffer_load_dwordx4 v[56:59], v103, s[52:55], s51 offen sc1
    s_waitcnt vmcnt(0)
    v_cmp_ne_u32 vcc, s4, v53
    v_cmp_ne_u32 s[68:69], s4, v55
    s_or_b64 s[68:69], s[68:69], vcc
    v_cmp_ne_u32 vcc, s4, v57
    s_or_b64 s[68:69], s[68:69], vcc
    v_cmp_ne_u32 vcc, s4, v59
    s_or_b64 s[68:69], s[68:69], vcc
    s_cbranch_scc0 L_h_stok
    s_sub_u32 s14, s14, 1
    s_cbranch_scc0 L_h_stpoll
L_h_stok:
    v_pk_mul_f32 v[8:9], v[98:99], v[52:53] op_sel:[0,0] op_sel_hi:[1,0]
    v_pk_mul_f32 v[60:61], v[100:101], v[56:57] op_sel:[0,0] op_sel_hi:[1,0]
    v_pk_fma_f32 v[8:9], v[98:99], v[54:55], v[8:9] op_sel:[1,0,0] op_sel_hi:[0,0,1] neg_lo:[1,0,0]
    v_pk_fma_f32 v[60:61], v[100:101], v[58:59], v[60:61] op_sel:[1,0,0] op_sel_hi:[0,0,1] neg_lo:[1,0,0]
    v_pk_add_f32 v[8:9], v[8:9], v[60:61]
L_h_stskip:
    ds_write_b64 v13, v[8:9] offset:12352
    s_waitcnt vmcnt(0)
    v_mfma_f32_32x32x16_bf16 v[112:127], v[128:131], v[104:107], 0
    v_mfma_f32_32x32x16_bf16 v[112:127], v[132:135], v[108:111], v[112:127]
    s_waitcnt lgkmcnt(0)
    s_add_u32 s73, s73, 4
    s_mov_b64 exec, 1
    ds_add_u32 v2, v3 offset:24
    s_mov_b64 exec, -1
L_wc22:
    ds_read_b32 v32, v2 offset:24
    s_waitcnt lgkmcnt(0)
    v_cmp_gt_u32 vcc, s73, v32
    s_cbranch_vccnz L_wc22
    ds_read_b64 v[32:33], v15 offset:12352
    ds_read_b64 v[34:35], v15 offset:12608
    ds_read_b64 v[36:37], v15 offset:12864
    ds_read_b64 v[38:39], v15 offset:13120
    ds_read_b64 v[40:41], v15 offset:13376
    ds_read_b64 v[42:43], v15 offset:13632
    ds_read_b64 v[44:45], v15 offset:13888
    ds_read_b64 v[46:47], v15 offset:14144
    s_lshl_b32 s9, s7, 2
    s_add_u32 s9, s9, s15
    s_lshl_b32 s13, s9, 16
    s_add_u32 s13, s13, 4194304
    s_lshl_b32 s10, s8, 11
    s_add_u32 s10, s10, s13
    s_add_u32 s11, s10, 32768
    s_lshl_b32 s9, s9, 11
    s_add_u32 s50, s9, 131072
    s_lshl_b32 s9, s8, 7
    s_add_u32 s0, s9, s50
    s_waitcnt lgkmcnt(0)
    v_pk_add_f32 v[32:33], v[32:33], v[40:41]
    v_pk_add_f32 v[34:35], v[34:35], v[42:43]
    v_pk_add_f32 v[36:37], v[36:37], v[44:45]
    v_pk_add_f32 v[38:39], v[38:39], v[46:47]
    v_pk_add_f32 v[32:33], v[32:33], v[36:37]
    v_pk_add_f32 v[34:35], v[34:35], v[38:39]
    v_pk_add_f32 v[32:33], v[32:33], v[34:35]
    v_pk_fma_f32 v[30:31], v[96:97], v[32:33], v[30:31] op_sel:[0,0,0] op_sel_hi:[0,1,1]
    v_pk_fma_f32 v[30:31], v[96:97], v[32:33], v[30:31] op_sel:[1,1,0] op_sel_hi:[1,0,1] neg_lo:[1,0,0]
    v_pk_fma_f32 v[64:65], v[20:21], v[30:31], v[64:65] op_sel:[0,0,0] op_sel_hi:[0,1,1]
    v_pk_fma_f32 v[64:65], v[20:21], v[30:31], v[64:65] op_sel:[1,1,0] op_sel_hi:[1,0,1] neg_lo:[1,0,0]
    v_pk_fma_f32 v[66:67], v[20:21], v[64:65], v[66:67] op_sel:[0,0,0] op_sel_hi:[0,1,1]
    v_pk_fma_f32 v[66:67], v[20:21], v[64:65], v[66:67] op_sel:[1,1,0] op_sel_hi:[1,0,1] neg_lo:[1,0,0]
    v_pk_fma_f32 v[68:69], v[20:21], v[66:67], v[68:69] op_sel:[0,0,0] op_sel_hi:[0,1,1]
    v_pk_fma_f32 v[68:69], v[20:21], v[66:67], v[68:69] op_sel:[1,1,0] op_sel_hi:[1,0,1] neg_lo:[1,0,0]
    v_pk_fma_f32 v[70:71], v[20:21], v[68:69], v[70:71] op_sel:[0,0,0] op_sel_hi:[0,1,1]
    v_pk_fma_f32 v[70:71], v[20:21], v[68:69], v[70:71] op_sel:[1,1,0] op_sel_hi:[1,0,1] neg_lo:[1,0,0]
    v_pk_fma_f32 v[72:73], v[20:21], v[70:71], v[72:73] op_sel:[0,0,0] op_sel_hi:[0,1,1]
    v_pk_fma_f32 v[72:73], v[20:21], v[70:71], v[72:73] op_sel:[1,1,0] op_sel_hi:[1,0,1] neg_lo:[1,0,0]
    v_pk_fma_f32 v[74:75], v[20:21], v[72:73], v[74:75] op_sel:[0,0,0] op_sel_hi:[0,1,1]
    v_pk_fma_f32 v[74:75], v[20:21], v[72:73], v[74:75] op_sel:[1,1,0] op_sel_hi:[1,0,1] neg_lo:[1,0,0]
    v_pk_fma_f32 v[76:77], v[20:21], v[74:75], v[76:77] op_sel:[0,0,0] op_sel_hi:[0,1,1]
    v_pk_fma_f32 v[76:77], v[20:21], v[74:75], v[76:77] op_sel:[1,1,0] op_sel_hi:[1,0,1] neg_lo:[1,0,0]
    v_pk_fma_f32 v[78:79], v[20:21], v[76:77], v[78:79] op_sel:[0,0,0] op_sel_hi:[0,1,1]
    v_pk_fma_f32 v[78:79], v[20:21], v[76:77], v[78:79] op_sel:[1,1,0] op_sel_hi:[1,0,1] neg_lo:[1,0,0]
    v_pk_fma_f32 v[80:81], v[20:21], v[78:79], v[80:81] op_sel:[0,0,0] op_sel_hi:[0,1,1]
    v_pk_fma_f32 v[80:81], v[20:21], v[78:79], v[80:81] op_sel:[1,1,0] op_sel_hi:[1,0,1] neg_lo:[1,0,0]
    v_pk_fma_f32 v[82:83], v[20:21], v[80:81], v[82:83] op_sel:[0,0,0] op_sel_hi:[0,1,1]
    v_pk_fma_f32 v[82:83], v[20:21], v[80:81], v[82:83] op_sel:[1,1,0] op_sel_hi:[1,0,1] neg_lo:[1,0,0]
    v_pk_fma_f32 v[84:85], v[20:21], v[82:83], v[84:85] op_sel:[0,0,0] op_sel_hi:[0,1,1]
    v_pk_fma_f32 v[84:85], v[20:21], v[82:83], v[84:85] op_sel:[1,1,0] op_sel_hi:[1,0,1] neg_lo:[1,0,0]
    v_pk_fma_f32 v[86:87], v[20:21], v[84:85], v[86:87] op_sel:[0,0,0] op_sel_hi:[0,1,1]
    v_pk_fma_f32 v[86:87], v[20:21], v[84:85], v[86:87] op_sel:[1,1,0] op_sel_hi:[1,0,1] neg_lo:[1,0,0]
    v_pk_fma_f32 v[88:89], v[20:21], v[86:87], v[88:89] op_sel:[0,0,0] op_sel_hi:[0,1,1]
    v_pk_fma_f32 v[88:89], v[20:21], v[86:87], v[88:89] op_sel:[1,1,0] op_sel_hi:[1,0,1] neg_lo:[1,0,0]
    v_pk_fma_f32 v[90:91], v[20:21], v[88:89], v[90:91] op_sel:[0,0,0] op_sel_hi:[0,1,1]
    v_pk_fma_f32 v[90:91], v[20:21], v[88:89], v[90:91] op_sel:[1,1,0] op_sel_hi:[1,0,1] neg_lo:[1,0,0]
    v_pk_fma_f32 v[92:93], v[20:21], v[90:91], v[92:93] op_sel:[0,0,0] op_sel_hi:[0,1,1]
    v_pk_fma_f32 v[92:93], v[20:21], v[90:91], v[92:93] op_sel:[1,1,0] op_sel_hi:[1,0,1] neg_lo:[1,0,0]
    v_pk_fma_f32 v[94:95], v[20:21], v[92:93], v[94:95] op_sel:[0,0,0] op_sel_hi:[0,1,1]
    v_pk_fma_f32 v[94:95], v[20:21], v[92:93], v[94:95] op_sel:[1,1,0] op_sel_hi:[1,0,1] neg_lo:[1,0,0]
    v_cvt_pk_bf16_f32 v32, v64, v66
    v_cvt_pk_bf16_f32 v33, v68, v70
    v_cvt_pk_bf16_f32 v34, v72, v74
    v_cvt_pk_bf16_f32 v35, v76, v78
    v_cvt_pk_bf16_f32 v36, v80, v82
    v_cvt_pk_bf16_f32 v37, v84, v86
    v_cvt_pk_bf16_f32 v38, v88, v90
    v_cvt_pk_bf16_f32 v39, v92, v94
    ds_write_b128 v16, v[32:35]
    ds_write_b128 v16, v[36:39] offset:16
    ds_read_b64_tr_b16 v[48:49], v19 offset:0
    ds_read_b64_tr_b16 v[50:51], v19 offset:256
    ds_read_b64_tr_b16 v[52:53], v19 offset:1024
    ds_read_b64_tr_b16 v[54:55], v19 offset:1280
    v_cvt_pk_bf16_f32 v40, -v65, -v67
    v_cvt_pk_bf16_f32 v41, -v69, -v71
    v_cvt_pk_bf16_f32 v42, -v73, -v75
    v_cvt_pk_bf16_f32 v43, -v77, -v79
    v_cvt_pk_bf16_f32 v44, -v81, -v83
    v_cvt_pk_bf16_f32 v45, -v85, -v87
    v_cvt_pk_bf16_f32 v46, -v89, -v91
    v_cvt_pk_bf16_f32 v47, -v93, -v95
    ds_write_b128 v16, v[40:43]
    ds_write_b128 v16, v[44:47] offset:16
    ds_read_b64_tr_b16 v[56:57], v19 offset:0
    ds_read_b64_tr_b16 v[58:59], v19 offset:256
    ds_read_b64_tr_b16 v[60:61], v19 offset:1024
    ds_read_b64_tr_b16 v[62:63], v19 offset:1280
    v_lshlrev_b32 v24, 2, v0
    v_mov_b32 v25, s4
    s_waitcnt lgkmcnt(0)
    buffer_store_dwordx4 v[48:51], v6, s[52:55], s10 offen offset:0 sc1
    buffer_store_dwordx4 v[52:55], v6, s[52:55], s10 offen offset:1024 sc1
    buffer_store_dwordx4 v[56:59], v6, s[52:55], s11 offen offset:0 sc1
    buffer_store_dwordx4 v[60:63], v6, s[52:55], s11 offen offset:1024 sc1
    v_and_b32 v8, 15, v0
    v_lshlrev_b32 v12, 7, v8
    s_setprio 0
    ds_read_b128 v[128:131], v28 offset:0
    ds_read_b128 v[132:135], v28 offset:32
    ds_read_b128 v[136:139], v28 offset:64
    ds_read_b128 v[140:143], v28 offset:96
    ds_read_b128 v[144:147], v28 offset:128
    ds_read_b128 v[148:151], v28 offset:160
    ds_read_b128 v[152:155], v28 offset:192
    ds_read_b128 v[156:159], v28 offset:224
    ds_read_b128 v[160:163], v28 offset:256
    ds_read_b128 v[164:167], v28 offset:288
    ds_read_b128 v[168:171], v28 offset:320
    ds_read_b128 v[172:175], v28 offset:352
    ds_read_b128 v[176:179], v28 offset:384
    ds_read_b128 v[180:183], v28 offset:416
    s_waitcnt vmcnt(0)
    s_mov_b32 exec_hi, 0
    buffer_store_dword v25, v24, s[52:55], s0 offen sc1
    s_mov_b64 exec, -1
    ds_read_b128 v[184:187], v28 offset:448
    ds_read_b128 v[188:191], v28 offset:480
    ds_read_b128 v[192:195], v28 offset:512
    ds_read_b128 v[196:199], v28 offset:544
    ds_read_b128 v[200:203], v28 offset:576
    ds_read_b128 v[204:207], v28 offset:608
    ds_read_b128 v[208:211], v28 offset:640
    ds_read_b128 v[212:215], v28 offset:672
    ds_read_b128 v[216:219], v28 offset:704
    ds_read_b128 v[220:223], v28 offset:736
    ds_read_b128 v[224:227], v28 offset:768
    ds_read_b128 v[228:231], v28 offset:800
    ds_read_b128 v[232:235], v28 offset:832
    ds_read_b128 v[236:239], v28 offset:864
    ds_read_b128 v[240:243], v28 offset:896
    ds_read_b128 v[244:247], v28 offset:928
    ds_read_b128 v[248:251], v28 offset:960
    ds_read_b128 v[252:255], v28 offset:992
    s_add_u32 s73, s73, 4
    s_mov_b64 exec, 1
    ds_add_u32 v2, v3 offset:24
    s_mov_b64 exec, -1
    s_setprio 2
    v_and_b32 v11, 12, v24
    v_add_u32 v11, 158720, v11
    s_mov_b32 s72, s15
    s_and_b32 s9, s72, 1
    s_lshl_b32 s10, s5, 1
    s_add_u32 s9, s9, s10
    s_lshl_b32 s9, s9, 2
    s_lshr_b32 s10, s72, 1
    s_add_u32 s9, s9, s10
    s_lshl_b32 s9, s9, 3
    s_add_u32 s9, s9, s6
    s_lshl_b32 s10, s9, 10
    s_add_u32 s10, s10, 1048576
    s_lshl_b32 s9, s9, 7
    s_add_u32 s9, s9, 524288
    s_mov_b32 s0, s9
    s_mov_b32 s1, s10
    s_mul_i32 s11, s15, 9216
    v_add_u32 v10, s11, v6
    s_add_u32 s9, s11, 8192
    s_mul_i32 s10, s15, 8320
L_wc23:
    ds_read_b32 v8, v2 offset:24
    s_waitcnt lgkmcnt(0)
    v_cmp_gt_u32 vcc, s73, v8
    s_cbranch_vccnz L_wc23
    s_add_u32 m0, s10, 73728
    s_add_u32 s11, s12, 0
    buffer_load_dwordx4 v6, s[60:63], s11 offen lds
L_wc24:
    ds_read_b32 v8, v11 offset:0
    s_waitcnt lgkmcnt(0)
    v_cmp_gt_u32 vcc, s9, v8
    s_cbranch_vccnz L_wc24
    s_add_u32 m0, s10, 74768
    s_add_u32 s11, s12, 1024
    buffer_load_dwordx4 v6, s[60:63], s11 offen lds
    ds_read_b128 v[20:23], v10 offset:8192
    ds_read_b128 v[32:35], v10 offset:0
    ds_read_b128 v[36:39], v10 offset:1024
    ds_read_b128 v[40:43], v10 offset:2048
    ds_read_b128 v[44:47], v10 offset:3072
    ds_read_b128 v[96:99], v10 offset:4096
    ds_read_b128 v[100:103], v10 offset:5120
    ds_read_b128 v[104:107], v10 offset:6144
    ds_read_b128 v[108:111], v10 offset:7168
    s_add_u32 m0, s10, 75808
    s_add_u32 s11, s12, 2048
    buffer_load_dwordx4 v6, s[60:63], s11 offen lds
    s_waitcnt lgkmcnt(8)
    v_pk_add_f32 v[20:21], v[20:21], v[22:23]
    v_add_f32 v20, v20, v21
    v_cmp_nle_f32 vcc, s78, v20
    v_cmp_nge_f32 s[68:69], s79, v20
    s_or_b64 vcc, vcc, s[68:69]
    s_cselect_b32 s0, 2048, s0
    s_cselect_b32 s1, 3072, s1
    v_rcp_f32 v22, v20
    s_waitcnt lgkmcnt(0)
    s_add_u32 m0, s10, 76848
    s_add_u32 s11, s12, 3072
    buffer_load_dwordx4 v6, s[60:63], s11 offen lds
    v_pk_add_f32 v[32:33], v[32:33], v[40:41]
    v_pk_add_f32 v[34:35], v[34:35], v[42:43]
    v_pk_add_f32 v[36:37], v[36:37], v[44:45]
    v_pk_add_f32 v[38:39], v[38:39], v[46:47]
    v_pk_add_f32 v[96:97], v[96:97], v[104:105]
    s_add_u32 m0, s10, 77888
    s_add_u32 s11, s12, 4096
    buffer_load_dwordx4 v6, s[60:63], s11 offen lds
    v_pk_add_f32 v[98:99], v[98:99], v[106:107]
    v_pk_add_f32 v[100:101], v[100:101], v[108:109]
    v_pk_add_f32 v[102:103], v[102:103], v[110:111]
    v_pk_add_f32 v[32:33], v[32:33], v[96:97]
    v_pk_add_f32 v[34:35], v[34:35], v[98:99]
    s_add_u32 m0, s10, 78928
    s_add_u32 s11, s12, 5120
    buffer_load_dwordx4 v6, s[60:63], s11 offen lds
    v_pk_add_f32 v[36:37], v[36:37], v[100:101]
    v_pk_add_f32 v[38:39], v[38:39], v[102:103]
    v_pk_mul_f32 v[32:33], v[32:33], v[22:23] op_sel_hi:[1,0]
    v_pk_mul_f32 v[34:35], v[34:35], v[22:23] op_sel_hi:[1,0]
    v_pk_mul_f32 v[36:37], v[36:37], v[22:23] op_sel_hi:[1,0]
    s_add_u32 m0, s10, 79968
    s_add_u32 s11, s12, 6144
    buffer_load_dwordx4 v6, s[60:63], s11 offen lds
    v_pk_mul_f32 v[38:39], v[38:39], v[22:23] op_sel_hi:[1,0]
    v_cvt_pk_bf16_f32 v40, v32, v33
    v_cvt_pk_bf16_f32 v41, v34, v35
    v_cvt_pk_bf16_f32 v42, v36, v37
    v_cvt_pk_bf16_f32 v43, v38, v39
    buffer_store_dwordx4 v[40:43], v6, s[52:55], s1 offen sc1
    s_add_u32 m0, s10, 81008
    s_add_u32 s11, s12, 7168
    buffer_load_dwordx4 v6, s[60:63], s11 offen lds
    s_mov_b32 s71, 0
L_rl25:
    s_mul_i32 s11, s71, 1040
    s_add_u32 s11, s11, s10
    s_add_u32 m0, s11, 107008
    s_lshl_b32 s11, s71, 10
    s_add_u32 s11, s11, s12
    s_add_u32 s11, s11, 32768
    buffer_load_dwordx4 v6, s[64:67], s11 offen lds
    s_add_u32 s71, s71, 1
    s_cmp_lt_u32 s71, 8
    s_cbranch_scc1 L_rl25
    v_add_u32 v13, 4294893568, v4
    s_lshl_b32 s50, s101, 11
    s_add_u32 s50, s50, 131072
    s_lshl_b32 s13, s101, 16
    s_and_b32 s10, s15, 1
    s_lshl_b32 s10, s10, 15
    s_add_u32 s13, s13, s10
    s_add_u32 s13, s13, 4194304
    s_mov_b32 s14, 400000
L_poll26:
    buffer_load_dword v8, v12, s[52:55], s50 offen sc1
    s_waitcnt vmcnt(0)
    v_cmp_ne_u32 vcc, s4, v8
    s_cbranch_vccz L_pdone27
    s_sub_u32 s14, s14, 1
    s_cbranch_scc0 L_poll26
L_pdone27:
    s_add_u32 s73, s73, 4
    s_mov_b64 exec, 1
    ds_add_u32 v2, v3 offset:24
    s_mov_b64 exec, -1
    s_mov_b32 exec_hi, 0
    buffer_store_dword v25, v24, s[52:55], s0 offen sc1
    s_mov_b64 exec, -1
    buffer_load_dwordx4 v[48:51], v6, s[52:55], s13 offen offset:0 sc1
    buffer_load_dwordx4 v[52:55], v6, s[52:55], s13 offen offset:1024 sc1
    buffer_load_dwordx4 v[56:59], v6, s[52:55], s13 offen offset:2048 sc1
    buffer_load_dwordx4 v[60:63], v6, s[52:55], s13 offen offset:3072 sc1
    s_add_u32 s13, s13, 4096
    buffer_load_dwordx4 v[64:67], v6, s[52:55], s13 offen offset:0 sc1
    buffer_load_dwordx4 v[68:71], v6, s[52:55], s13 offen offset:1024 sc1
    buffer_load_dwordx4 v[72:75], v6, s[52:55], s13 offen offset:2048 sc1
    buffer_load_dwordx4 v[76:79], v6, s[52:55], s13 offen offset:3072 sc1
    s_add_u32 s13, s13, 4096
    buffer_load_dwordx4 v[80:83], v6, s[52:55], s13 offen offset:0 sc1
    buffer_load_dwordx4 v[84:87], v6, s[52:55], s13 offen offset:1024 sc1
    buffer_load_dwordx4 v[88:91], v6, s[52:55], s13 offen offset:2048 sc1
    s_lshl_b32 s50, s96, 12
    s_add_u32 s50, s50, 524288
    s_lshl_b32 s51, s96, 15
    s_add_u32 s51, s51, 1048576
L_wc28:
    ds_read_b32 v8, v2 offset:24
    s_waitcnt lgkmcnt(0)
    v_cmp_gt_u32 vcc, s73, v8
    s_cbranch_vccnz L_wc28
    s_setprio 0
    ds_read_b128 v[96:99], v28 offset:0
    ds_read_b128 v[100:103], v28 offset:32
    ds_read_b128 v[104:107], v28 offset:64
    buffer_load_dwordx4 v[92:95], v6, s[52:55], s13 offen offset:3072 sc1
    ds_read_b128 v[108:111], v28 offset:96
    s_waitcnt vmcnt(11) lgkmcnt(3)
    v_mfma_f32_32x32x16_bf16 v[112:127], v[48:51], v[96:99], v[112:127]
    v_mfma_f32_32x32x16_bf16 v[32:47], v[48:51], v[128:131], 0
    s_add_u32 s13, s13, 4096
    buffer_load_dwordx4 v[48:51], v6, s[52:55], s13 offen offset:0 sc1
    ds_read_b128 v[96:99], v28 offset:128
    s_waitcnt vmcnt(11) lgkmcnt(3)
    v_mfma_f32_32x32x16_bf16 v[112:127], v[52:55], v[100:103], v[112:127]
    v_mfma_f32_32x32x16_bf16 v[32:47], v[52:55], v[132:135], v[32:47]
    buffer_load_dwordx4 v[52:55], v6, s[52:55], s13 offen offset:1024 sc1
    ds_read_b128 v[100:103], v28 offset:160
    s_waitcnt vmcnt(11) lgkmcnt(3)
    v_mfma_f32_32x32x16_bf16 v[112:127], v[56:59], v[104:107], v[112:127]
    v_mfma_f32_32x32x16_bf16 v[32:47], v[56:59], v[136:139], v[32:47]
    buffer_load_dwordx4 v[56:59], v6, s[52:55], s13 offen offset:2048 sc1
    ds_read_b128 v[104:107], v28 offset:192
    s_waitcnt vmcnt(11) lgkmcnt(3)
    v_mfma_f32_32x32x16_bf16 v[112:127], v[60:63], v[108:111], v[112:127]
    v_mfma_f32_32x32x16_bf16 v[32:47], v[60:63], v[140:143], v[32:47]
    s_and_b32 s9, s15, 1
    s_lshl_b32 s9, s9, 18
    s_lshr_b32 s10, s15, 1
    s_lshl_b32 s10, s10, 14
    s_add_u32 s9, s9, s10
    s_lshl_b32 s10, s6, 7
    s_add_u32 s9, s9, s10
    s_mul_i32 s10, s15, 9216
    buffer_load_dwordx4 v[60:63], v6, s[52:55], s13 offen offset:3072 sc1
    ds_read_b128 v[108:111], v28 offset:224
    s_waitcnt vmcnt(11) lgkmcnt(3)
    v_mfma_f32_32x32x16_bf16 v[112:127], v[64:67], v[96:99], v[112:127]
    v_mfma_f32_32x32x16_bf16 v[32:47], v[64:67], v[144:147], v[32:47]
    s_add_u32 s13, s13, 4096
    buffer_load_dwordx4 v[64:67], v6, s[52:55], s13 offen offset:0 sc1
    ds_read_b128 v[96:99], v28 offset:256
    s_waitcnt vmcnt(11) lgkmcnt(3)
    v_mfma_f32_32x32x16_bf16 v[112:127], v[68:71], v[100:103], v[112:127]
    s_add_u32 m0, s10, 0
    s_add_u32 s11, s9, 0
    buffer_load_dwordx4 v7, s[56:59], s11 offen lds
    v_mfma_f32_32x32x16_bf16 v[32:47], v[68:71], v[148:151], v[32:47]
    buffer_load_dwordx4 v[68:71], v6, s[52:55], s13 offen offset:1024 sc1
    ds_read_b128 v[100:103], v28 offset:288
    s_waitcnt vmcnt(12) lgkmcnt(3)
    v_mfma_f32_32x32x16_bf16 v[112:127], v[72:75], v[104:107], v[112:127]
    s_add_u32 m0, s10, 1024
    s_add_u32 s11, s9, 8192
    buffer_load_dwordx4 v7, s[56:59], s11 offen lds
    v_mfma_f32_32x32x16_bf16 v[32:47], v[72:75], v[152:155], v[32:47]
    buffer_load_dwordx4 v[72:75], v6, s[52:55], s13 offen offset:2048 sc1
    ds_read_b128 v[104:107], v28 offset:320
    s_waitcnt vmcnt(13) lgkmcnt(3)
    v_mfma_f32_32x32x16_bf16 v[112:127], v[76:79], v[108:111], v[112:127]
    s_add_u32 m0, s10, 2048
    s_add_u32 s11, s9, 65536
    buffer_load_dwordx4 v7, s[56:59], s11 offen lds
    v_mfma_f32_32x32x16_bf16 v[32:47], v[76:79], v[156:159], v[32:47]
    buffer_load_dwordx4 v[76:79], v6, s[52:55], s13 offen offset:3072 sc1
    ds_read_b128 v[108:111], v28 offset:352
    s_waitcnt vmcnt(14) lgkmcnt(3)
    v_mfma_f32_32x32x16_bf16 v[112:127], v[80:83], v[96:99], v[112:127]
    s_add_u32 m0, s10, 3072
    s_add_u32 s11, s9, 73728
    buffer_load_dwordx4 v7, s[56:59], s11 offen lds
    v_mfma_f32_32x32x16_bf16 v[32:47], v[80:83], v[160:163], v[32:47]
    s_add_u32 s13, s13, 4096
    buffer_load_dwordx4 v[80:83], v6, s[52:55], s13 offen offset:0 sc1
    ds_read_b128 v[96:99], v28 offset:384
    s_waitcnt vmcnt(15) lgkmcnt(3)
    v_mfma_f32_32x32x16_bf16 v[112:127], v[84:87], v[100:103], v[112:127]
    s_add_u32 m0, s10, 4096
    s_add_u32 s11, s9, 131072
    buffer_load_dwordx4 v7, s[56:59], s11 offen lds
    v_mfma_f32_32x32x16_bf16 v[32:47], v[84:87], v[164:167], v[32:47]
    buffer_load_dwordx4 v[84:87], v6, s[52:55], s13 offen offset:1024 sc1
    ds_read_b128 v[100:103], v28 offset:416
    s_waitcnt vmcnt(16) lgkmcnt(3)
    v_mfma_f32_32x32x16_bf16 v[112:127], v[88:91], v[104:107], v[112:127]
    s_add_u32 m0, s10, 5120
    s_add_u32 s11, s9, 139264
    buffer_load_dwordx4 v7, s[56:59], s11 offen lds
    v_mfma_f32_32x32x16_bf16 v[32:47], v[88:91], v[168:171], v[32:47]
    buffer_load_dwordx4 v[88:91], v6, s[52:55], s13 offen offset:2048 sc1
    ds_read_b128 v[104:107], v28 offset:448
    s_waitcnt vmcnt(17) lgkmcnt(3)
    v_mfma_f32_32x32x16_bf16 v[112:127], v[92:95], v[108:111], v[112:127]
    s_add_u32 m0, s10, 6144
    s_add_u32 s11, s9, 196608
    buffer_load_dwordx4 v7, s[56:59], s11 offen lds
    v_mfma_f32_32x32x16_bf16 v[32:47], v[92:95], v[172:175], v[32:47]
    buffer_load_dwordx4 v[92:95], v6, s[52:55], s13 offen offset:3072 sc1
    ds_read_b128 v[108:111], v28 offset:480
    s_waitcnt vmcnt(18) lgkmcnt(3)
    v_mfma_f32_32x32x16_bf16 v[112:127], v[48:51], v[96:99], v[112:127]
    s_add_u32 m0, s10, 7168
    s_add_u32 s11, s9, 204800
    buffer_load_dwordx4 v7, s[56:59], s11 offen lds
    v_mfma_f32_32x32x16_bf16 v[32:47], v[48:51], v[176:179], v[32:47]
    s_add_u32 s13, s13, 4096
    buffer_load_dwordx4 v[48:51], v6, s[52:55], s13 offen offset:0 sc1
    ds_read_b128 v[96:99], v28 offset:512
    s_waitcnt vmcnt(19) lgkmcnt(3)
    v_mfma_f32_32x32x16_bf16 v[112:127], v[52:55], v[100:103], v[112:127]
    v_mfma_f32_32x32x16_bf16 v[32:47], v[52:55], v[180:183], v[32:47]
    buffer_load_dword v9, v12, s[52:55], s50 offen sc1
    buffer_load_dwordx4 v[52:55], v6, s[52:55], s13 offen offset:1024 sc1
    ds_read_b128 v[100:103], v28 offset:544
    s_waitcnt vmcnt(20) lgkmcnt(3)
    v_mfma_f32_32x32x16_bf16 v[112:127], v[56:59], v[104:107], v[112:127]
    v_mfma_f32_32x32x16_bf16 v[32:47], v[56:59], v[184:187], v[32:47]
    buffer_load_dwordx4 v[56:59], v6, s[52:55], s13 offen offset:2048 sc1
    ds_read_b128 v[104:107], v28 offset:576
    s_waitcnt vmcnt(20) lgkmcnt(3)
    v_mfma_f32_32x32x16_bf16 v[112:127], v[60:63], v[108:111], v[112:127]
    v_mfma_f32_32x32x16_bf16 v[32:47], v[60:63], v[188:191], v[32:47]
    buffer_load_dwordx4 v[60:63], v6, s[52:55], s13 offen offset:3072 sc1
    ds_read_b128 v[108:111], v28 offset:608
    s_waitcnt vmcnt(20) lgkmcnt(3)
    v_mfma_f32_32x32x16_bf16 v[112:127], v[64:67], v[96:99], v[112:127]
    v_mfma_f32_32x32x16_bf16 v[32:47], v[64:67], v[192:195], v[32:47]
    s_add_u32 s13, s13, 4096
    buffer_load_dwordx4 v[64:67], v6, s[52:55], s13 offen offset:0 sc1
    ds_read_b128 v[96:99], v28 offset:640
    s_waitcnt vmcnt(19) lgkmcnt(3)
    v_mfma_f32_32x32x16_bf16 v[112:127], v[68:71], v[100:103], v[112:127]
    v_mfma_f32_32x32x16_bf16 v[32:47], v[68:71], v[196:199], v[32:47]
    buffer_load_dwordx4 v[68:71], v6, s[52:55], s13 offen offset:1024 sc1
    ds_read_b128 v[100:103], v28 offset:672
    s_waitcnt vmcnt(18) lgkmcnt(3)
    v_mfma_f32_32x32x16_bf16 v[112:127], v[72:75], v[104:107], v[112:127]
    v_mfma_f32_32x32x16_bf16 v[32:47], v[72:75], v[200:203], v[32:47]
    s_waitcnt vmcnt(5)
    s_setprio 2
    v_cmp_ne_u32 vcc, s4, v9
    s_cbranch_vccz L_y_ok
    s_mov_b32 s14, 400000
L_poll29:
    buffer_load_dword v8, v12, s[52:55], s50 offen sc1
    s_waitcnt vmcnt(0)
    v_cmp_ne_u32 vcc, s4, v8
    s_cbranch_vccz L_pdone30
    s_sub_u32 s14, s14, 1
    s_cbranch_scc0 L_poll29
L_pdone30:
L_y_ok:
    s_setprio 0
    buffer_load_dwordx4 v[72:75], v6, s[52:55], s13 offen offset:2048 sc1
    ds_read_b128 v[104:107], v28 offset:704
    s_waitcnt lgkmcnt(3)
    v_mfma_f32_32x32x16_bf16 v[112:127], v[76:79], v[108:111], v[112:127]
    buffer_load_dwordx4 v[128:131], v6, s[52:55], s51 offen offset:0 sc1
    v_mfma_f32_32x32x16_bf16 v[32:47], v[76:79], v[204:207], v[32:47]
    buffer_load_dwordx4 v[76:79], v6, s[52:55], s13 offen offset:3072 sc1
    ds_read_b128 v[108:111], v28 offset:736
    s_waitcnt lgkmcnt(3)
    v_mfma_f32_32x32x16_bf16 v[112:127], v[80:83], v[96:99], v[112:127]
    buffer_load_dwordx4 v[132:135], v6, s[52:55], s51 offen offset:1024 sc1
    v_mfma_f32_32x32x16_bf16 v[32:47], v[80:83], v[208:211], v[32:47]
    ds_read_b128 v[96:99], v28 offset:768
    s_waitcnt lgkmcnt(3)
    v_mfma_f32_32x32x16_bf16 v[112:127], v[84:87], v[100:103], v[112:127]
    buffer_load_dwordx4 v[136:139], v6, s[52:55], s51 offen offset:2048 sc1
    buffer_load_dwordx4 v[140:143], v6, s[52:55], s51 offen offset:3072 sc1
    v_mfma_f32_32x32x16_bf16 v[32:47], v[84:87], v[212:215], v[32:47]
    ds_read_b128 v[100:103], v28 offset:800
    s_waitcnt lgkmcnt(3)
    v_mfma_f32_32x32x16_bf16 v[112:127], v[88:91], v[104:107], v[112:127]
    s_add_u32 s51, s51, 4096
    buffer_load_dwordx4 v[144:147], v6, s[52:55], s51 offen offset:0 sc1
    buffer_load_dwordx4 v[148:151], v6, s[52:55], s51 offen offset:1024 sc1
    v_mfma_f32_32x32x16_bf16 v[32:47], v[88:91], v[216:219], v[32:47]
    ds_read_b128 v[104:107], v28 offset:832
    s_waitcnt lgkmcnt(3)
    v_mfma_f32_32x32x16_bf16 v[112:127], v[92:95], v[108:111], v[112:127]
    buffer_load_dwordx4 v[152:155], v6, s[52:55], s51 offen offset:2048 sc1
    buffer_load_dwordx4 v[156:159], v6, s[52:55], s51 offen offset:3072 sc1
    v_mfma_f32_32x32x16_bf16 v[32:47], v[92:95], v[220:223], v[32:47]
    ds_read_b128 v[108:111], v28 offset:864
    s_waitcnt lgkmcnt(3)
    v_mfma_f32_32x32x16_bf16 v[112:127], v[48:51], v[96:99], v[112:127]
    s_add_u32 s51, s51, 4096
    buffer_load_dwordx4 v[160:163], v6, s[52:55], s51 offen offset:0 sc1
    buffer_load_dwordx4 v[164:167], v6, s[52:55], s51 offen offset:1024 sc1
    v_mfma_f32_32x32x16_bf16 v[32:47], v[48:51], v[224:227], v[32:47]
    ds_read_b128 v[96:99], v28 offset:896
    s_waitcnt vmcnt(16) lgkmcnt(3)
    v_mfma_f32_32x32x16_bf16 v[112:127], v[52:55], v[100:103], v[112:127]
    buffer_load_dwordx4 v[168:171], v6, s[52:55], s51 offen offset:2048 sc1
    buffer_load_dwordx4 v[172:175], v6, s[52:55], s51 offen offset:3072 sc1
    v_mfma_f32_32x32x16_bf16 v[32:47], v[52:55], v[228:231], v[32:47]
    ds_read_b128 v[100:103], v28 offset:928
    s_waitcnt vmcnt(17) lgkmcnt(3)
    v_mfma_f32_32x32x16_bf16 v[112:127], v[56:59], v[104:107], v[112:127]
    s_add_u32 s51, s51, 4096
    buffer_load_dwordx4 v[176:179], v6, s[52:55], s51 offen offset:0 sc1
    buffer_load_dwordx4 v[180:183], v6, s[52:55], s51 offen offset:1024 sc1
    v_mfma_f32_32x32x16_bf16 v[32:47], v[56:59], v[232:235], v[32:47]
    ds_read_b128 v[104:107], v28 offset:960
    s_waitcnt vmcnt(18) lgkmcnt(3)
    v_mfma_f32_32x32x16_bf16 v[112:127], v[60:63], v[108:111], v[112:127]
    buffer_load_dwordx4 v[184:187], v6, s[52:55], s51 offen offset:2048 sc1
    buffer_load_dwordx4 v[188:191], v6, s[52:55], s51 offen offset:3072 sc1
    v_mfma_f32_32x32x16_bf16 v[32:47], v[60:63], v[236:239], v[32:47]
    ds_read_b128 v[108:111], v28 offset:992
    s_waitcnt vmcnt(19) lgkmcnt(3)
    v_mfma_f32_32x32x16_bf16 v[112:127], v[64:67], v[96:99], v[112:127]
    v_mfma_f32_32x32x16_bf16 v[32:47], v[64:67], v[240:243], v[32:47]
    s_waitcnt vmcnt(18) lgkmcnt(2)
    v_mfma_f32_32x32x16_bf16 v[112:127], v[68:71], v[100:103], v[112:127]
    v_mfma_f32_32x32x16_bf16 v[32:47], v[68:71], v[244:247], v[32:47]
    s_waitcnt vmcnt(17) lgkmcnt(1)
    v_mfma_f32_32x32x16_bf16 v[112:127], v[72:75], v[104:107], v[112:127]
    v_mfma_f32_32x32x16_bf16 v[32:47], v[72:75], v[248:251], v[32:47]
    s_waitcnt vmcnt(15) lgkmcnt(0)
    v_mfma_f32_32x32x16_bf16 v[112:127], v[76:79], v[108:111], v[112:127]
    v_mfma_f32_32x32x16_bf16 v[32:47], v[76:79], v[252:255], v[32:47]
    s_setprio 2
    s_lshl_b32 s11, s15, 12
    s_add_u32 s11, s11, 114688
    v_add_u32 v10, s11, v6
    v_xor_b32 v11, 4096, v10
    s_lshl_b32 s11, s15, 9
    s_add_u32 s11, s11, 160832
    v_lshlrev_b32 v8, 3, v0
    v_add_u32 v8, s11, v8
    ds_write2_b32 v8, v4, v1 offset1:1
    s_waitcnt lgkmcnt(0)
    s_add_u32 s73, s73, 4
    s_mov_b64 exec, 1
    ds_add_u32 v2, v3 offset:24
    s_mov_b64 exec, -1
L_wc31:
    ds_read_b32 v8, v2 offset:24
    s_waitcnt lgkmcnt(0)
    v_cmp_gt_u32 vcc, s73, v8
    s_cbranch_vccnz L_wc31
    s_add_u32 m0, s10, 73728
    s_add_u32 s11, s9, 32768
    buffer_load_dwordx4 v7, s[56:59], s11 offen lds
    ds_write_b128 v10, v[32:35] offset:0
    s_add_u32 m0, s10, 74752
    s_add_u32 s11, s9, 40960
    buffer_load_dwordx4 v7, s[56:59], s11 offen lds
    ds_write_b128 v10, v[36:39] offset:1024
    s_add_u32 m0, s10, 75776
    s_add_u32 s11, s9, 98304
    buffer_load_dwordx4 v7, s[56:59], s11 offen lds
    ds_write_b128 v10, v[40:43] offset:2048
    s_add_u32 m0, s10, 76800
    s_add_u32 s11, s9, 106496
    buffer_load_dwordx4 v7, s[56:59], s11 offen lds
    ds_write_b128 v10, v[44:47] offset:3072
    s_add_u32 s73, s73, 4
    s_mov_b64 exec, 1
    ds_add_u32 v2, v3 offset:24
    s_mov_b64 exec, -1
    s_add_u32 m0, s10, 77824
    s_add_u32 s11, s9, 163840
    buffer_load_dwordx4 v7, s[56:59], s11 offen lds
    s_waitcnt vmcnt(6)
    s_add_u32 m0, s10, 78848
    s_add_u32 s11, s9, 172032
    buffer_load_dwordx4 v7, s[56:59], s11 offen lds
    s_waitcnt vmcnt(6)
    s_add_u32 m0, s10, 79872
    s_add_u32 s11, s9, 229376
    buffer_load_dwordx4 v7, s[56:59], s11 offen lds
    s_waitcnt vmcnt(6)
    s_add_u32 m0, s10, 80896
    s_add_u32 s11, s9, 237568
    buffer_load_dwordx4 v7, s[56:59], s11 offen lds
    s_mov_b32 s60, s44
    s_and_b32 s61, s45, 0xffff
    s_mov_b32 s62, 8388608
    s_mov_b32 s63, 0x20000
    s_lshl_b32 s9, s101, 17
    s_lshl_b32 s10, s97, 7
    s_add_u32 s9, s9, s10
    s_mul_i32 s11, s15, 9216
    v_add_u32 v10, s11, v6
    s_lshl_b32 s11, s15, 2
    v_add_u32 v9, s11, v2
L_wc32:
    ds_read_b32 v8, v2 offset:24
    s_waitcnt lgkmcnt(0)
    v_cmp_gt_u32 vcc, s73, v8
    s_cbranch_vccnz L_wc32
    ds_read_b128 v[192:195], v11 offset:0
    ds_read_b128 v[196:199], v11 offset:1024
    ds_read_b128 v[200:203], v11 offset:2048
    ds_read_b128 v[204:207], v11 offset:3072
    s_setprio 0
    ds_read_b64_tr_b16 v[48:49], v13 offset:0
    ds_read_b64_tr_b16 v[50:51], v13 offset:1024
    ds_read_b64_tr_b16 v[52:53], v13 offset:2048
    ds_read_b64_tr_b16 v[54:55], v13 offset:3072
    ds_read_b64_tr_b16 v[56:57], v13 offset:4096
    ds_read_b64_tr_b16 v[58:59], v13 offset:5120
    ds_read_b64_tr_b16 v[60:61], v13 offset:6144
    ds_read_b64_tr_b16 v[62:63], v13 offset:7168
    ds_read_b64_tr_b16 v[64:65], v13 offset:9216
    ds_read_b64_tr_b16 v[66:67], v13 offset:10240
    ds_read_b64_tr_b16 v[68:69], v13 offset:11264
    ds_read_b64_tr_b16 v[70:71], v13 offset:12288
    ds_read_b64_tr_b16 v[72:73], v13 offset:13312
    ds_read_b64_tr_b16 v[74:75], v13 offset:14336
    ds_read_b64_tr_b16 v[76:77], v13 offset:15360
    ds_read_b64_tr_b16 v[78:79], v13 offset:16384
    ds_read_b64_tr_b16 v[80:81], v13 offset:18432
    ds_read_b64_tr_b16 v[82:83], v13 offset:19456
    ds_read_b64_tr_b16 v[84:85], v13 offset:20480
    ds_read_b64_tr_b16 v[86:87], v13 offset:21504
    ds_read_b64_tr_b16 v[88:89], v13 offset:22528
    ds_read_b64_tr_b16 v[90:91], v13 offset:23552
    ds_read_b64_tr_b16 v[92:93], v13 offset:24576
    ds_read_b64_tr_b16 v[94:95], v13 offset:25600
    ds_read_b64_tr_b16 v[96:97], v13 offset:27648
    ds_read_b64_tr_b16 v[98:99], v13 offset:28672
    ds_read_b64_tr_b16 v[100:101], v13 offset:29696
    ds_read_b64_tr_b16 v[102:103], v13 offset:30720
    ds_read_b64_tr_b16 v[104:105], v13 offset:31744
    ds_read_b64_tr_b16 v[106:107], v13 offset:32768
    ds_read_b64_tr_b16 v[108:109], v13 offset:33792
    ds_read_b64_tr_b16 v[110:111], v13 offset:34816
    s_setprio 2
    s_waitcnt vmcnt(0) lgkmcnt(15)
    s_add_u32 s73, s73, 4
    s_mov_b64 exec, 1
    ds_add_u32 v2, v3 offset:24
    s_mov_b64 exec, -1
    v_pk_add_f32 v[112:113], v[112:113], v[192:193]
    v_pk_add_f32 v[114:115], v[114:115], v[194:195]
    v_pk_add_f32 v[116:117], v[116:117], v[196:197]
    v_pk_add_f32 v[118:119], v[118:119], v[198:199]
    v_pk_add_f32 v[120:121], v[120:121], v[200:201]
    v_pk_add_f32 v[122:123], v[122:123], v[202:203]
    v_pk_add_f32 v[124:125], v[124:125], v[204:205]
    v_pk_add_f32 v[126:127], v[126:127], v[206:207]
    s_waitcnt lgkmcnt(0)
    s_setprio 0
    v_mfma_f32_32x32x16_bf16 v[32:47], v[128:131], v[48:51], 0
    s_add_u32 s10, s9, 0
    buffer_store_dword v112, v1, s[60:63], s10 offen offset:2048 nt
    v_mfma_f32_32x32x16_bf16 v[32:47], v[132:135], v[52:55], v[32:47]
    s_add_u32 s10, s9, 4096
    buffer_store_dword v113, v1, s[60:63], s10 offen offset:2048 nt
    v_mfma_f32_32x32x16_bf16 v[32:47], v[136:139], v[56:59], v[32:47]
    s_add_u32 s10, s9, 8192
    buffer_store_dword v114, v1, s[60:63], s10 offen offset:2048 nt
    v_mfma_f32_32x32x16_bf16 v[32:47], v[140:143], v[60:63], v[32:47]
    s_add_u32 s10, s9, 12288
    buffer_store_dword v115, v1, s[60:63], s10 offen offset:2048 nt
    v_mfma_f32_32x32x16_bf16 v[32:47], v[144:147], v[64:67], v[32:47]
    s_add_u32 s10, s9, 32768
    buffer_store_dword v116, v1, s[60:63], s10 offen offset:2048 nt
    v_mfma_f32_32x32x16_bf16 v[32:47], v[148:151], v[68:71], v[32:47]
    s_add_u32 s10, s9, 36864
    buffer_store_dword v117, v1, s[60:63], s10 offen offset:2048 nt
    v_mfma_f32_32x32x16_bf16 v[32:47], v[152:155], v[72:75], v[32:47]
    s_add_u32 s10, s9, 40960
    buffer_store_dword v118, v1, s[60:63], s10 offen offset:2048 nt
    v_mfma_f32_32x32x16_bf16 v[32:47], v[156:159], v[76:79], v[32:47]
    s_add_u32 s10, s9, 45056
    buffer_store_dword v119, v1, s[60:63], s10 offen offset:2048 nt
    v_mfma_f32_32x32x16_bf16 v[32:47], v[160:163], v[80:83], v[32:47]
    s_add_u32 s10, s9, 65536
    buffer_store_dword v120, v1, s[60:63], s10 offen offset:2048 nt
    v_mfma_f32_32x32x16_bf16 v[32:47], v[164:167], v[84:87], v[32:47]
    s_add_u32 s10, s9, 69632
    buffer_store_dword v121, v1, s[60:63], s10 offen offset:2048 nt
    v_mfma_f32_32x32x16_bf16 v[32:47], v[168:171], v[88:91], v[32:47]
    s_add_u32 s10, s9, 73728
    buffer_store_dword v122, v1, s[60:63], s10 offen offset:2048 nt
    v_mfma_f32_32x32x16_bf16 v[32:47], v[172:175], v[92:95], v[32:47]
    s_add_u32 s10, s9, 77824
    buffer_store_dword v123, v1, s[60:63], s10 offen offset:2048 nt
    v_mfma_f32_32x32x16_bf16 v[32:47], v[176:179], v[96:99], v[32:47]
    s_add_u32 s10, s9, 98304
    buffer_store_dword v124, v1, s[60:63], s10 offen offset:2048 nt
    v_mfma_f32_32x32x16_bf16 v[32:47], v[180:183], v[100:103], v[32:47]
    s_add_u32 s10, s9, 102400
    buffer_store_dword v125, v1, s[60:63], s10 offen offset:2048 nt
    v_mfma_f32_32x32x16_bf16 v[32:47], v[184:187], v[104:107], v[32:47]
    s_add_u32 s10, s9, 106496
    buffer_store_dword v126, v1, s[60:63], s10 offen offset:2048 nt
    v_mfma_f32_32x32x16_bf16 v[32:47], v[188:191], v[108:111], v[32:47]
    s_add_u32 s10, s9, 110592
    buffer_store_dword v127, v1, s[60:63], s10 offen offset:2048 nt
    s_setprio 2
L_wc33:
    ds_read_b32 v8, v2 offset:24
    s_waitcnt lgkmcnt(0)
    v_cmp_gt_u32 vcc, s73, v8
    s_cbranch_vccnz L_wc33
    s_nop 6
    ds_write_b128 v10, v[32:35] offset:0
    ds_write_b128 v10, v[36:39] offset:1024
    ds_write_b128 v10, v[40:43] offset:2048
    ds_write_b128 v10, v[44:47] offset:3072
    ds_write_b32 v9, v3 offset:48
    s_branch L_end
L_slow:
    s_waitcnt lgkmcnt(0)
    s_mov_b32 s71, 0
    s_lshl_b32 s9, s72, 10
    s_add_u32 s9, s9, 150528
    v_add_u32 v4, s9, v14
    ds_read_b128 v[8:11], v4
    v_mov_b32 v4, 0xff800000
    v_lshrrev_b32 v16, 5, v0
    v_and_b32 v17, 15, v0
    v_lshl_add_u32 v15, v16, 4, v17
    v_lshlrev_b32 v15, 4, v15
    s_mov_b32 s68, 0xffff
    s_mov_b32 s69, 0xffff
    s_mov_b32 s9, 262144
L_slow_p1:
    buffer_load_dwordx4 v[64:67], v14, s[52:55], s9 offen offset:0 sc1
    buffer_load_dwordx4 v[76:79], v14, s[52:55], s9 offen offset:2048 sc1
    s_mov_b64 exec, s[68:69]
    buffer_load_dwordx4 v[68:71], v15, s[52:55], s9 offen offset:1024 sc1
    buffer_load_dwordx4 v[72:75], v15, s[52:55], s9 offen offset:1536 sc1
    buffer_load_dwordx4 v[80:83], v15, s[52:55], s9 offen offset:3072 sc1
    buffer_load_dwordx4 v[84:87], v15, s[52:55], s9 offen offset:3584 sc1
    s_mov_b64 exec, -1
    s_add_u32 s9, s9, 4096
    s_waitcnt vmcnt(0) lgkmcnt(0)
    v_mfma_f32_32x32x16_bf16 v[16:31], v[64:67], v[8:11], 0
    s_nop 11
    v_max3_f32 v4, v16, v17, v4
    v_max3_f32 v4, v18, v19, v4
    v_max3_f32 v4, v20, v21, v4
    v_max3_f32 v4, v22, v23, v4
    v_max3_f32 v4, v24, v25, v4
    v_max3_f32 v4, v26, v27, v4
    v_max3_f32 v4, v28, v29, v4
    v_max3_f32 v4, v30, v31, v4
    v_mfma_f32_32x32x16_bf16 v[16:31], v[76:79], v[8:11], 0
    s_nop 11
    v_max3_f32 v4, v16, v17, v4
    v_max3_f32 v4, v18, v19, v4
    v_max3_f32 v4, v20, v21, v4
    v_max3_f32 v4, v22, v23, v4
    v_max3_f32 v4, v24, v25, v4
    v_max3_f32 v4, v26, v27, v4
    v_max3_f32 v4, v28, v29, v4
    v_max3_f32 v4, v30, v31, v4
    s_cmp_lt_u32 s9, 393216
    s_cbranch_scc1 L_slow_p1
    v_mov_b32 v5, v4
    s_nop 1
    v_permlane32_swap_b32 v4, v5
    v_max_f32 v4, v4, v5
    v_sub_f32 v32, 0, v4
    v_sub_f32 v33, 0, v4
    v_sub_f32 v34, 0, v4
    v_sub_f32 v35, 0, v4
    v_sub_f32 v36, 0, v4
    v_sub_f32 v37, 0, v4
    v_sub_f32 v38, 0, v4
    v_sub_f32 v39, 0, v4
    v_sub_f32 v40, 0, v4
    v_sub_f32 v41, 0, v4
    v_sub_f32 v42, 0, v4
    v_sub_f32 v43, 0, v4
    v_sub_f32 v44, 0, v4
    v_sub_f32 v45, 0, v4
    v_sub_f32 v46, 0, v4
    v_sub_f32 v47, 0, v4
    v_mfma_f32_32x32x8_bf16 v[48:63], v[2:3], v[2:3], 0
    s_mov_b32 s9, 262144
L_slow_p2:
    buffer_load_dwordx4 v[64:67], v14, s[52:55], s9 offen offset:0 sc1
    buffer_load_dwordx4 v[76:79], v14, s[52:55], s9 offen offset:2048 sc1
    s_mov_b64 exec, s[68:69]
    buffer_load_dwordx4 v[68:71], v15, s[52:55], s9 offen offset:1024 sc1
    buffer_load_dwordx4 v[72:75], v15, s[52:55], s9 offen offset:1536 sc1
    buffer_load_dwordx4 v[80:83], v15, s[52:55], s9 offen offset:3072 sc1
    buffer_load_dwordx4 v[84:87], v15, s[52:55], s9 offen offset:3584 sc1
    s_mov_b64 exec, -1
    s_add_u32 s9, s9, 4096
    s_waitcnt vmcnt(0)
    v_mfma_f32_32x32x16_bf16 v[16:31], v[64:67], v[8:11], v[32:47]
    s_nop 11
    v_exp_f32 v16, v16
    v_exp_f32 v17, v17
    v_exp_f32 v18, v18
    v_exp_f32 v19, v19
    v_exp_f32 v20, v20
    v_exp_f32 v21, v21
    v_exp_f32 v22, v22
    v_exp_f32 v23, v23
    v_exp_f32 v24, v24
    v_exp_f32 v25, v25
    v_exp_f32 v26, v26
    v_exp_f32 v27, v27
    v_exp_f32 v28, v28
    v_exp_f32 v29, v29
    v_exp_f32 v30, v30
    v_exp_f32 v31, v31
    s_nop 1
    v_smfmac_f32_32x32x32_bf16 v[48:63], v[68:71], v[16:23], v1
    v_smfmac_f32_32x32x32_bf16 v[48:63], v[72:75], v[24:31], v1
    v_mfma_f32_32x32x16_bf16 v[16:31], v[76:79], v[8:11], v[32:47]
    s_nop 11
    v_exp_f32 v16, v16
    v_exp_f32 v17, v17
    v_exp_f32 v18, v18
    v_exp_f32 v19, v19
    v_exp_f32 v20, v20
    v_exp_f32 v21, v21
    v_exp_f32 v22, v22
    v_exp_f32 v23, v23
    v_exp_f32 v24, v24
    v_exp_f32 v25, v25
    v_exp_f32 v26, v26
    v_exp_f32 v27, v27
    v_exp_f32 v28, v28
    v_exp_f32 v29, v29
    v_exp_f32 v30, v30
    v_exp_f32 v31, v31
    s_nop 1
    v_smfmac_f32_32x32x32_bf16 v[48:63], v[80:83], v[16:23], v1
    v_smfmac_f32_32x32x32_bf16 v[48:63], v[84:87], v[24:31], v1
    s_cmp_lt_u32 s9, 393216
    s_cbranch_scc1 L_slow_p2
    s_and_b32 s9, s72, 1
    s_lshl_b32 s10, s5, 1
    s_add_u32 s9, s9, s10
    s_lshl_b32 s9, s9, 2
    s_lshr_b32 s10, s72, 1
    s_add_u32 s9, s9, s10
    s_lshl_b32 s9, s9, 3
    s_add_u32 s9, s9, s6
    s_lshl_b32 s10, s9, 10
    s_add_u32 s10, s10, 1048576
    s_lshl_b32 s9, s9, 7
    s_add_u32 s9, s9, 524288
    v_rcp_f32 v4, v56
    s_nop 0
    v_pk_mul_f32 v[48:49], v[48:49], v[4:5] op_sel_hi:[1,0]
    v_pk_mul_f32 v[50:51], v[50:51], v[4:5] op_sel_hi:[1,0]
    v_pk_mul_f32 v[52:53], v[52:53], v[4:5] op_sel_hi:[1,0]
    v_pk_mul_f32 v[54:55], v[54:55], v[4:5] op_sel_hi:[1,0]
    v_cvt_pk_bf16_f32 v16, v48, v49
    v_cvt_pk_bf16_f32 v17, v50, v51
    v_cvt_pk_bf16_f32 v18, v52, v53
    v_cvt_pk_bf16_f32 v19, v54, v55
    buffer_store_dwordx4 v[16:19], v14, s[52:55], s10 offen sc1
    s_waitcnt vmcnt(0)
    v_mov_b32 v16, 0
    v_mov_b32 v17, s4
    s_mov_b64 exec, 1
    buffer_store_dword v17, v16, s[52:55], s9 offen sc1
    s_mov_b64 exec, -1
    v_and_b32 v15, 15, v0
    v_lshlrev_b32 v15, 7, v15
    v_lshlrev_b32 v7, 3, v0
    v_add_u32 v7, s50, v7
    s_lshl_b32 s9, s15, 2
    v_add_u32 v10, s9, v12
    s_cmp_lt_u32 s72, 4
    s_cbranch_scc1 L_a_ok2
    ds_read_b128 v[56:59], v6 offset:8192
    s_waitcnt lgkmcnt(0)
    s_branch L_a_ok1
L_a_bad1:
    s_waitcnt lgkmcnt(0)
    s_sub_u32 s72, 7, s15
    s_branch L_slow
L_a_bad2:
    s_mov_b32 s72, s15
    s_branch L_slow
L_end:
L_exit:
    s_endpgm
.section .rodata,"a"
.p2align 6
.amdhsa_kernel concat_heads__grouped_kv_mqa__ssm_conv_s5__prompt_kernel
  .amdhsa_next_free_vgpr 256
  .amdhsa_next_free_sgpr 102
  .amdhsa_accum_offset 256
  .amdhsa_group_segment_fixed_size 0
  .amdhsa_kernarg_size 136
  .amdhsa_user_sgpr_count 2
  .amdhsa_user_sgpr_kernarg_segment_ptr 1
  .amdhsa_system_sgpr_workgroup_id_x 1
.end_amdhsa_kernel
```
